```python
import torch

def _softmax(x, axis=-1):
    return torch.softmax(x, dim=axis)
def _gelu(x):
    return torch.nn.functional.gelu(x, approximate="tanh")
def _silu(x):
    return torch.nn.functional.silu(x)
def _sigmoid(x):
    return torch.sigmoid(x)
def _layernorm(x, axis=-1, eps=1e-5):
    m = x.mean(dim=axis, keepdim=True)
    v = x.var(dim=axis, keepdim=True, unbiased=False)
    return (x - m) / torch.sqrt(v + eps)
def _scatter_add(tgt, idx, src, axis=0):
    return tgt.clone().index_add_(axis, idx, src)
def _segment_sum(src, seg, n):
    out = torch.zeros((n,) + src.shape[1:], dtype=src.dtype)
    return out.index_add_(0, seg, src)
def _pad(x, pw):
    flat = tuple(v for pair in reversed(pw) for v in pair)
    return torch.nn.functional.pad(x, flat)

kernel_name = 'gated_mix__linear_kernel_hedgehog__ssm_conv_s4__prompt'

def setup_inputs():

    _w = (lambda a: (lambda t: t.to(torch.bfloat16) if t.is_floating_point() else t)(torch.as_tensor(a)))
    def _A_setup():
        B, S, D, H = 1, 2048, 448, 16
        Dh = D // H
        return {
            "x": _w((lambda *s: torch.randn(*s, dtype=torch.bfloat16) * 0.05)(B, S, D)),
            "wqkv": _w((lambda *s: torch.randn(*s, dtype=torch.bfloat16) * 0.8)(D, 3 * D)),
            "w_phi": _w((lambda *s: torch.randn(*s, dtype=torch.bfloat16) * 0.8)(H, Dh, Dh) * (Dh ** -0.5)),
            "wo": _w((lambda *s: torch.randn(*s, dtype=torch.bfloat16) * 0.05)(D, D)),
        }
    _A_in = _A_setup()

    def _B_setup():
        B, L, D, N = 1, 2048, 448, 256
        A_re = -(lambda _x: torch.exp(torch.as_tensor(_x)))((lambda *s: torch.randn(*s, dtype=torch.bfloat16) * 6.4)(D, N))
        A_im = torch.pi * (lambda *s: torch.randn(*s, dtype=torch.bfloat16) * 0.05)(D, N)
        B_re = (lambda *s: torch.randn(*s, dtype=torch.bfloat16) * 0.1)(D, N)
        B_im = (lambda *s: torch.randn(*s, dtype=torch.bfloat16) * 0.1)(D, N)
        C_re = (lambda *s: torch.randn(*s, dtype=torch.bfloat16) * 0.1)(D, N)
        C_im = (lambda *s: torch.randn(*s, dtype=torch.bfloat16) * 0.1)(D, N)
        log_dt = (lambda *s: torch.randn(*s, dtype=torch.bfloat16) * 0.05)(D) * 0.5 - 4.0
        Dskip = (lambda *s: torch.randn(*s, dtype=torch.bfloat16) * 0.05)(D)
        return {
            "u": _w((lambda *s: torch.randn(*s, dtype=torch.bfloat16) * 0.05)(B, L, D)),
            "A_re": _w(A_re),
            "A_im": _w(A_im),
            "B_re": _w(B_re),
            "B_im": _w(B_im),
            "C_re": _w(C_re),
            "C_im": _w(C_im),
            "log_dt": _w(log_dt),
            "Dskip": _w(Dskip),
        }
    _B_in = _B_setup()

    return {
        "A_x": _A_in["x"],
        "A_wqkv": _A_in["wqkv"],
        "A_w_phi": _A_in["w_phi"],
        "A_wo": _A_in["wo"],
        "B_u": _B_in["u"],
        "B_A_re": _B_in["A_re"],
        "B_A_im": _B_in["A_im"],
        "B_B_re": _B_in["B_re"],
        "B_B_im": _B_in["B_im"],
        "B_C_re": _B_in["C_re"],
        "B_C_im": _B_in["C_im"],
        "B_log_dt": _B_in["log_dt"],
        "B_Dskip": _B_in["Dskip"],
        "gate_w": _w((lambda *s: torch.randn(*s, dtype=torch.bfloat16) * 0.05)(448) * 16.0),
    }

def reference(A_x, A_wqkv, A_w_phi, A_wo, B_u, B_A_re, B_A_im, B_B_re, B_B_im, B_C_re, B_C_im, B_log_dt, B_Dskip, gate_w):
    def _A_ref(x, wqkv, w_phi, wo):
        B, S, D = x.shape
        H = 16; Dh = D // H
        qkv = (lambda x, *d: x.permute(*d))((x @ wqkv).reshape(B, S, 3, H, Dh), 2, 0, 3, 1, 4)
        q, k, v = qkv[0], qkv[1], qkv[2]
        pq = torch.einsum("bhsd,hdf->bhsf", q, w_phi)
        pk = torch.einsum("bhsd,hdf->bhsf", k, w_phi)
        phi_q = torch.concatenate([_softmax(pq, axis=-1), _softmax(-pq, axis=-1)], axis=-1)
        phi_k = torch.concatenate([_softmax(pk, axis=-1), _softmax(-pk, axis=-1)], axis=-1)
        kv = torch.einsum("bhsf,bhsd->bhfd", phi_k, v)
        z  = torch.einsum("bhsf->bhf", phi_k)
        num = torch.einsum("bhqf,bhfd->bhqd", phi_q, kv)
        den = torch.einsum("bhqf,bhf->bhq", phi_q, z)[..., None] + 1e-6
        o = num / den
        return (lambda x, *d: x.permute(*d))(o, 0, 2, 1, 3).reshape(B, S, D) @ wo

    def _B_ref(u, A_re, A_im, B_re, B_im, C_re, C_im, log_dt, Dskip):
        Bsz, L, D = u.shape
        dt = torch.exp(log_dt)[:, None]
        A = A_re + 1j * A_im
        Bc = B_re + 1j * B_im
        Cc = C_re + 1j * C_im
        logdA = dt * A
        dB = dt * Bc
        l = (lambda x, dt: x.to(dt))(torch.arange(L), A_re.dtype)
        P = torch.exp(logdA[:, :, None] * l[None, None, :])
        K = torch.einsum("dn,dnl,dn->dl", Cc, P, dB).real
        L2 = 2 * L
        Kp = _pad(K, ((0, 0), (0, L)))
        up = (lambda x, *d: x.permute(*d))(u, 0, 2, 1)
        up = _pad(up, ((0, 0), (0, 0), (0, L)))
        Kf = (lambda x, axes=(-2,-1): torch.fft.rfft2(x.float(), dim=axes))(Kp[:, None, :], axes=(-2, -1))
        Uf = (lambda x, axes=(-2,-1): torch.fft.rfft2(x.float(), dim=axes))(up[:, :, None, :], axes=(-2, -1))
        Yf = Uf * Kf[None, :, :, :]
        y = (lambda x, s, axes=(-2,-1): torch.fft.irfft2(x, s=s, dim=axes).to(torch.bfloat16))(Yf, (1, L2), axes=(-2, -1))[:, :, 0, :L]
        y = (lambda x, *d: x.permute(*d))(y, 0, 2, 1) + u * Dskip[None, None, :]
        return y

    x = A_x
    g = _sigmoid((x * gate_w).sum(-1, keepdims=True))
    a = _A_ref(x, A_wqkv, A_w_phi, A_wo)
    b = _B_ref(x, B_A_re, B_A_im, B_B_re, B_B_im, B_C_re, B_C_im, B_log_dt, B_Dskip)
    return g * a + (1 - g) * b
```

```asm
; @launch grid=(480,1,1) block=(256,1,1) lds=81920
.amdgcn_target "amdgcn-amd-amdhsa--gfx950"
.text
.globl gated_mix__linear_kernel_hedgehog__ssm_conv_s4__prompt_kernel
.p2align 8
.type gated_mix__linear_kernel_hedgehog__ssm_conv_s4__prompt_kernel,@function
gated_mix__linear_kernel_hedgehog__ssm_conv_s4__prompt_kernel:
    s_load_dwordx16 s[16:31], s[0:1], 0
    s_load_dwordx16 s[32:47], s[0:1], 64
    s_load_dwordx2 s[48:49], s[0:1], 128
    v_lshrrev_b32 v1, 6, v0
    s_cmp_ge_u32 s2, 480
    s_cbranch_scc1 L_exit
    v_readfirstlane_b32 s14, v1
    v_and_b32 v1, 63, v0
    s_waitcnt lgkmcnt(0)
    s_mov_b32 s4, s48
    s_mov_b32 s5, s49
    s_mov_b32 s6, 0x2000000
    s_mov_b32 s7, 0x00020000
    s_or_b32 s58, s2, s14
    s_cmp_lg_u32 s58, 0
    s_cbranch_scc1 L_nn
    s_memrealtime s[60:61]
    s_waitcnt lgkmcnt(0)
    s_or_b32 s60, s60, 1
    v_mov_b32 v4, s60
    v_mov_b32 v5, s61
    v_mov_b32 v6, 0
    v_mov_b32 v7, 0
    v_mov_b32 v8, 0
    s_mov_b64 exec, 1
    global_atomic_cmpswap_x2 v8, v[4:7], s[46:47] sc1
    s_mov_b64 exec, -1
L_nn:
    s_cmp_ge_u32 s2, 224
    s_cbranch_scc1 L_A
L_S:
    s_setprio 0
    s_mul_hi_u32 s50, s2, 0x24924925
    s_mul_i32 s51, s50, 7
    s_sub_u32 s51, s2, s51
    s_mul_i32 s52, s50, 57344
    s_lshl_b32 s53, s51, 7
    s_add_u32 s52, s52, s53
    s_add_u32 s54, s16, s52
    s_addc_u32 s55, s17, 0
    v_lshrrev_b32 v2, 2, v0
    v_and_b32 v3, 3, v0
    v_mul_u32_u24 v4, 896, v2
    v_lshl_add_u32 v4, v3, 5, v4
    global_load_dwordx4 v[16:19], v4, s[54:55]
    global_load_dwordx4 v[20:23], v4, s[54:55] offset:16
    s_lshl_b32 s57, s2, 10
    v_lshlrev_b32 v5, 2, v0
    v_add_u32 v5, s57, v5
    global_load_dword v32, v5, s[26:27]
    global_load_dword v33, v5, s[28:29]
    global_load_dword v34, v5, s[30:31]
    global_load_dword v35, v5, s[32:33]
    global_load_dword v36, v5, s[34:35]
    global_load_dword v37, v5, s[36:37]
    s_lshl_b32 s57, s2, 2
    s_load_dword s56, s[38:39], s57
    v_mov_b32 v254, 0
    global_load_dwordx2 v[252:253], v254, s[46:47] sc0 sc1
    v_mul_u32_u24 v6, 144, v2
    v_lshl_add_u32 v6, v3, 5, v6
    v_add_u32 v6, 33792, v6
    v_lshrrev_b32 v2, 4, v1
    v_and_b32 v3, 15, v1
    v_lshrrev_b32 v7, 2, v3
    v_lshl_add_u32 v7, v2, 3, v7
    v_mul_u32_u24 v7, 144, v7
    v_and_b32 v8, 3, v1
    v_lshl_add_u32 v7, v8, 3, v7
    s_lshl_b32 s58, s14, 5
    s_add_u32 s58, s58, 33792
    v_add_u32 v7, s58, v7
    s_lshl_b32 s58, s51, 6
    s_lshl_b32 s59, s14, 4
    s_add_u32 s58, s58, s59
    v_add_u32 v8, s58, v3
    s_movk_i32 s59, 4128
    v_mul_lo_u32 v8, v8, s59
    s_lshl_b32 s58, s50, 7
    s_add_u32 s58, s58, 16
    v_lshl_add_u32 v9, v2, 4, v8
    v_add_u32 v9, s58, v9
    v_lshlrev_b32 v10, 3, v0
    v_add_u32 v110, 7, v10
    v_add_u32 v111, 6, v10
    v_add_u32 v112, 5, v10
    v_add_u32 v113, 4, v10
    v_add_u32 v114, 3, v10
    v_add_u32 v115, 2, v10
    v_add_u32 v116, 1, v10
    v_add_u32 v117, 0, v10
    v_cvt_f32_u32 v244, v110
    v_cvt_f32_u32 v245, v111
    v_cvt_f32_u32 v246, v112
    v_cvt_f32_u32 v247, v113
    v_cvt_f32_u32 v248, v114
    v_cvt_f32_u32 v249, v115
    v_cvt_f32_u32 v250, v116
    v_cvt_f32_u32 v251, v117
    v_cvt_pk_bf16_f32 v120, v244, v245
    v_cvt_pk_bf16_f32 v121, v246, v247
    v_cvt_pk_bf16_f32 v122, v248, v249
    v_cvt_pk_bf16_f32 v123, v250, v251
    v_cmp_gt_u32 vcc, 32, v0
    v_and_b32 v244, 0xffff, v120
    v_subrev_u32 v244, 17024, v244
    v_cndmask_b32 v244, v244, v110, vcc
    v_lshlrev_b32 v244, 2, v244
    v_lshrrev_b32 v245, 16, v120
    v_subrev_u32 v245, 17024, v245
    v_cndmask_b32 v245, v245, v111, vcc
    v_lshlrev_b32 v245, 2, v245
    v_and_b32 v246, 0xffff, v121
    v_subrev_u32 v246, 17024, v246
    v_cndmask_b32 v246, v246, v112, vcc
    v_lshlrev_b32 v246, 2, v246
    v_lshrrev_b32 v247, 16, v121
    v_subrev_u32 v247, 17024, v247
    v_cndmask_b32 v247, v247, v113, vcc
    v_lshlrev_b32 v247, 2, v247
    v_and_b32 v248, 0xffff, v122
    v_subrev_u32 v248, 17024, v248
    v_cndmask_b32 v248, v248, v114, vcc
    v_lshlrev_b32 v248, 2, v248
    v_lshrrev_b32 v249, 16, v122
    v_subrev_u32 v249, 17024, v249
    v_cndmask_b32 v249, v249, v115, vcc
    v_lshlrev_b32 v249, 2, v249
    v_and_b32 v250, 0xffff, v123
    v_subrev_u32 v250, 17024, v250
    v_cndmask_b32 v250, v250, v116, vcc
    v_lshlrev_b32 v250, 2, v250
    v_lshrrev_b32 v251, 16, v123
    v_subrev_u32 v251, 17024, v251
    v_cndmask_b32 v251, v251, v117, vcc
    v_lshlrev_b32 v251, 2, v251
    s_waitcnt vmcnt(7)
    ds_write_b128 v6, v[16:19]
    ds_write_b128 v6, v[20:23] offset:16
    s_waitcnt lgkmcnt(0)
    s_barrier
    ds_read_b64_tr_b16 v[24:25], v7 offset:0
    ds_read_b64_tr_b16 v[26:27], v7 offset:576
    ds_read_b64_tr_b16 v[28:29], v7 offset:4608
    ds_read_b64_tr_b16 v[30:31], v7 offset:5184
    s_waitcnt vmcnt(1) lgkmcnt(0)
    buffer_store_dwordx4 v[24:27], v9, s[4:7], 0 offen sc0 sc1
    buffer_store_dwordx4 v[28:31], v9, s[4:7], 0 offen offset:64 sc0 sc1
    s_cmp_lg_u32 s50, 0
    s_cbranch_scc1 L_nz_1
    v_mov_b32 v12, 0
    v_mov_b32 v13, 0
    v_mov_b32 v14, 0
    v_mov_b32 v15, 0
    s_mov_b64 exec, 0xffff
    buffer_store_dwordx4 v[12:15], v8, s[4:7], 0 offen sc0 sc1
    s_mov_b64 exec, -1
L_nz_1:
    s_waitcnt lgkmcnt(0)
    s_lshl_b32 s58, s56, 16
    s_and_b32 s59, s56, 0xffff0000
    s_cmp_ge_u32 s14, 2
    s_cselect_b32 s58, s59, s58
    v_mov_b32 v40, s58
    v_mul_f32 v41, 0x3fb8aa3b, v40
    s_mov_b32 s59, 0x3fb8aa3b
    v_fma_f32 v42, v40, s59, -v41
    v_mul_f32 v43, 0x32a57060, v40
    v_add_f32 v42, v42, v43
    v_exp_f32 v41, v41
    v_mul_f32 v42, 0x3f317218, v42
    v_fma_f32 v41, v41, v42, v41
    v_cvt_pk_bf16_f32 v41, v41, v41
    v_lshlrev_b32 v38, 16, v41
    v_lshlrev_b32 v40, 16, v32
    v_lshlrev_b32 v41, 16, v33
    v_lshlrev_b32 v42, 16, v34
    v_lshlrev_b32 v43, 16, v35
    v_lshlrev_b32 v44, 16, v36
    v_lshlrev_b32 v45, 16, v37
    v_and_b32 v70, 0xffff0000, v32
    v_and_b32 v71, 0xffff0000, v33
    v_and_b32 v72, 0xffff0000, v34
    v_and_b32 v73, 0xffff0000, v35
    v_and_b32 v74, 0xffff0000, v36
    v_and_b32 v75, 0xffff0000, v37
    v_mul_f32 v40, v40, v38
    v_mul_f32 v41, v41, v38
    v_mul_f32 v42, v42, v38
    v_mul_f32 v43, v43, v38
    v_mul_f32 v70, v70, v38
    v_mul_f32 v71, v71, v38
    v_mul_f32 v72, v72, v38
    v_mul_f32 v73, v73, v38
    v_mul_f32 v40, 0x3fb8aa3b, v40
    v_mul_f32 v41, 0x3e22f983, v41
    v_pk_mul_f32 v[46:47], v[44:45], v[42:43] op_sel:[0,0] op_sel_hi:[0,1]
    v_mul_f32 v70, 0x3fb8aa3b, v70
    v_mul_f32 v71, 0x3e22f983, v71
    v_pk_mul_f32 v[76:77], v[74:75], v[72:73] op_sel:[0,0] op_sel_hi:[0,1]
    v_pk_fma_f32 v[46:47], v[44:45], v[42:43], v[46:47] op_sel:[1,1,0] op_sel_hi:[1,0,1] neg_lo:[1,0,0]
    v_pk_fma_f32 v[76:77], v[74:75], v[72:73], v[76:77] op_sel:[1,1,0] op_sel_hi:[1,0,1] neg_lo:[1,0,0]
    v_mul_f32 v48, 0x41000000, v40
    v_mul_f32 v49, 0x41000000, v41
    v_mul_f32 v78, 0x41000000, v70
    v_mul_f32 v79, 0x41000000, v71
    v_exp_f32 v48, v48
    v_fract_f32 v49, v49
    v_exp_f32 v78, v78
    v_fract_f32 v79, v79
    v_cos_f32 v50, v49
    v_sin_f32 v51, v49
    v_cos_f32 v80, v79
    v_sin_f32 v81, v79
    v_pk_mul_f32 v[66:67], v[50:51], v[48:49] op_sel_hi:[1,0]
    v_pk_mul_f32 v[96:97], v[80:81], v[78:79] op_sel_hi:[1,0]
    v_mul_f32 v48, 0x3f800000, v40
    v_mul_f32 v49, 0x3f800000, v41
    v_mul_f32 v78, 0x3f800000, v70
    v_mul_f32 v79, 0x3f800000, v71
    v_exp_f32 v48, v48
    v_fract_f32 v49, v49
    v_exp_f32 v78, v78
    v_fract_f32 v79, v79
    v_cos_f32 v50, v49
    v_sin_f32 v51, v49
    v_cos_f32 v80, v79
    v_sin_f32 v81, v79
    v_pk_mul_f32 v[52:53], v[50:51], v[48:49] op_sel_hi:[1,0]
    v_pk_mul_f32 v[82:83], v[80:81], v[78:79] op_sel_hi:[1,0]
    v_mul_f32 v48, 0x43000000, v40
    v_mul_f32 v49, 0x43000000, v41
    v_mul_f32 v78, 0x43000000, v70
    v_mul_f32 v79, 0x43000000, v71
    v_exp_f32 v48, v48
    v_fract_f32 v49, v49
    v_exp_f32 v78, v78
    v_fract_f32 v79, v79
    v_cos_f32 v50, v49
    v_sin_f32 v51, v49
    v_cos_f32 v80, v79
    v_sin_f32 v81, v79
    v_pk_mul_f32 v[100:101], v[50:51], v[48:49] op_sel_hi:[1,0]
    v_pk_mul_f32 v[118:119], v[80:81], v[78:79] op_sel_hi:[1,0]
    s_mul_i32 s62, s14, 8448
    v_lshlrev_b32 v12, 3, v1
    v_add_u32 v12, s62, v12
    v_mul_u32_u24 v13, 528, v3
    v_and_b32 v14, 1, v2
    v_lshl_add_u32 v13, v14, 8, v13
    v_lshrrev_b32 v14, 1, v2
    v_lshl_add_u32 v13, v14, 7, v13
    v_add_u32 v13, s62, v13
    v_cvt_pk_bf16_f32 v152, v46, v47
    v_cvt_pk_bf16_f32 v153, v76, v77
    ds_write_b64 v12, v[152:153] offset:0
    v_pk_mul_f32 v[42:43], v[46:47], v[66:67] op_sel:[0,0] op_sel_hi:[0,1]
    v_pk_mul_f32 v[72:73], v[76:77], v[96:97] op_sel:[0,0] op_sel_hi:[0,1]
    v_pk_mul_f32 v[54:55], v[52:53], v[52:53] op_sel:[0,0] op_sel_hi:[0,1]
    v_pk_mul_f32 v[84:85], v[82:83], v[82:83] op_sel:[0,0] op_sel_hi:[0,1]
    v_pk_fma_f32 v[42:43], v[46:47], v[66:67], v[42:43] op_sel:[1,1,0] op_sel_hi:[1,0,1] neg_lo:[1,0,0]
    v_pk_fma_f32 v[72:73], v[76:77], v[96:97], v[72:73] op_sel:[1,1,0] op_sel_hi:[1,0,1] neg_lo:[1,0,0]
    v_pk_fma_f32 v[54:55], v[52:53], v[52:53], v[54:55] op_sel:[1,1,0] op_sel_hi:[1,0,1] neg_lo:[1,0,0]
    v_pk_fma_f32 v[84:85], v[82:83], v[82:83], v[84:85] op_sel:[1,1,0] op_sel_hi:[1,0,1] neg_lo:[1,0,0]
    v_cvt_pk_bf16_f32 v154, v42, v43
    v_cvt_pk_bf16_f32 v155, v72, v73
    ds_write_b64 v12, v[154:155] offset:528
    v_pk_mul_f32 v[68:69], v[42:43], v[66:67] op_sel:[0,0] op_sel_hi:[0,1]
    v_pk_mul_f32 v[98:99], v[72:73], v[96:97] op_sel:[0,0] op_sel_hi:[0,1]
    v_pk_mul_f32 v[102:103], v[100:101], v[100:101] op_sel:[0,0] op_sel_hi:[0,1]
    v_pk_mul_f32 v[120:121], v[118:119], v[118:119] op_sel:[0,0] op_sel_hi:[0,1]
    v_pk_fma_f32 v[68:69], v[42:43], v[66:67], v[68:69] op_sel:[1,1,0] op_sel_hi:[1,0,1] neg_lo:[1,0,0]
    v_pk_fma_f32 v[98:99], v[72:73], v[96:97], v[98:99] op_sel:[1,1,0] op_sel_hi:[1,0,1] neg_lo:[1,0,0]
    v_pk_fma_f32 v[102:103], v[100:101], v[100:101], v[102:103] op_sel:[1,1,0] op_sel_hi:[1,0,1] neg_lo:[1,0,0]
    v_pk_fma_f32 v[120:121], v[118:119], v[118:119], v[120:121] op_sel:[1,1,0] op_sel_hi:[1,0,1] neg_lo:[1,0,0]
    v_cvt_pk_bf16_f32 v156, v68, v69
    v_cvt_pk_bf16_f32 v157, v98, v99
    ds_write_b64 v12, v[156:157] offset:1056
    v_pk_mul_f32 v[42:43], v[68:69], v[66:67] op_sel:[0,0] op_sel_hi:[0,1]
    v_pk_mul_f32 v[72:73], v[98:99], v[96:97] op_sel:[0,0] op_sel_hi:[0,1]
    v_pk_mul_f32 v[56:57], v[54:55], v[52:53] op_sel:[0,0] op_sel_hi:[0,1]
    v_pk_mul_f32 v[86:87], v[84:85], v[82:83] op_sel:[0,0] op_sel_hi:[0,1]
    v_pk_fma_f32 v[42:43], v[68:69], v[66:67], v[42:43] op_sel:[1,1,0] op_sel_hi:[1,0,1] neg_lo:[1,0,0]
    v_pk_fma_f32 v[72:73], v[98:99], v[96:97], v[72:73] op_sel:[1,1,0] op_sel_hi:[1,0,1] neg_lo:[1,0,0]
    v_pk_fma_f32 v[56:57], v[54:55], v[52:53], v[56:57] op_sel:[1,1,0] op_sel_hi:[1,0,1] neg_lo:[1,0,0]
    v_pk_fma_f32 v[86:87], v[84:85], v[82:83], v[86:87] op_sel:[1,1,0] op_sel_hi:[1,0,1] neg_lo:[1,0,0]
    v_cvt_pk_bf16_f32 v158, v42, v43
    v_cvt_pk_bf16_f32 v159, v72, v73
    ds_write_b64 v12, v[158:159] offset:1584
    v_pk_mul_f32 v[68:69], v[42:43], v[66:67] op_sel:[0,0] op_sel_hi:[0,1]
    v_pk_mul_f32 v[98:99], v[72:73], v[96:97] op_sel:[0,0] op_sel_hi:[0,1]
    v_pk_mul_f32 v[58:59], v[54:55], v[54:55] op_sel:[0,0] op_sel_hi:[0,1]
    v_pk_mul_f32 v[88:89], v[84:85], v[84:85] op_sel:[0,0] op_sel_hi:[0,1]
    v_pk_fma_f32 v[68:69], v[42:43], v[66:67], v[68:69] op_sel:[1,1,0] op_sel_hi:[1,0,1] neg_lo:[1,0,0]
    v_pk_fma_f32 v[98:99], v[72:73], v[96:97], v[98:99] op_sel:[1,1,0] op_sel_hi:[1,0,1] neg_lo:[1,0,0]
    v_pk_fma_f32 v[58:59], v[54:55], v[54:55], v[58:59] op_sel:[1,1,0] op_sel_hi:[1,0,1] neg_lo:[1,0,0]
    v_pk_fma_f32 v[88:89], v[84:85], v[84:85], v[88:89] op_sel:[1,1,0] op_sel_hi:[1,0,1] neg_lo:[1,0,0]
    v_cvt_pk_bf16_f32 v152, v68, v69
    v_cvt_pk_bf16_f32 v153, v98, v99
    ds_write_b64 v12, v[152:153] offset:2112
    v_pk_mul_f32 v[42:43], v[68:69], v[66:67] op_sel:[0,0] op_sel_hi:[0,1]
    v_pk_mul_f32 v[72:73], v[98:99], v[96:97] op_sel:[0,0] op_sel_hi:[0,1]
    v_pk_mul_f32 v[104:105], v[102:103], v[100:101] op_sel:[0,0] op_sel_hi:[0,1]
    v_pk_mul_f32 v[122:123], v[120:121], v[118:119] op_sel:[0,0] op_sel_hi:[0,1]
    v_pk_fma_f32 v[42:43], v[68:69], v[66:67], v[42:43] op_sel:[1,1,0] op_sel_hi:[1,0,1] neg_lo:[1,0,0]
    v_pk_fma_f32 v[72:73], v[98:99], v[96:97], v[72:73] op_sel:[1,1,0] op_sel_hi:[1,0,1] neg_lo:[1,0,0]
    v_pk_fma_f32 v[104:105], v[102:103], v[100:101], v[104:105] op_sel:[1,1,0] op_sel_hi:[1,0,1] neg_lo:[1,0,0]
    v_pk_fma_f32 v[122:123], v[120:121], v[118:119], v[122:123] op_sel:[1,1,0] op_sel_hi:[1,0,1] neg_lo:[1,0,0]
    v_cvt_pk_bf16_f32 v154, v42, v43
    v_cvt_pk_bf16_f32 v155, v72, v73
    ds_write_b64 v12, v[154:155] offset:2640
    v_pk_mul_f32 v[68:69], v[42:43], v[66:67] op_sel:[0,0] op_sel_hi:[0,1]
    v_pk_mul_f32 v[98:99], v[72:73], v[96:97] op_sel:[0,0] op_sel_hi:[0,1]
    v_pk_mul_f32 v[106:107], v[102:103], v[102:103] op_sel:[0,0] op_sel_hi:[0,1]
    v_pk_mul_f32 v[124:125], v[120:121], v[120:121] op_sel:[0,0] op_sel_hi:[0,1]
    v_pk_fma_f32 v[68:69], v[42:43], v[66:67], v[68:69] op_sel:[1,1,0] op_sel_hi:[1,0,1] neg_lo:[1,0,0]
    v_pk_fma_f32 v[98:99], v[72:73], v[96:97], v[98:99] op_sel:[1,1,0] op_sel_hi:[1,0,1] neg_lo:[1,0,0]
    v_pk_fma_f32 v[106:107], v[102:103], v[102:103], v[106:107] op_sel:[1,1,0] op_sel_hi:[1,0,1] neg_lo:[1,0,0]
    v_pk_fma_f32 v[124:125], v[120:121], v[120:121], v[124:125] op_sel:[1,1,0] op_sel_hi:[1,0,1] neg_lo:[1,0,0]
    v_cvt_pk_bf16_f32 v156, v68, v69
    v_cvt_pk_bf16_f32 v157, v98, v99
    ds_write_b64 v12, v[156:157] offset:3168
    v_pk_mul_f32 v[42:43], v[68:69], v[66:67] op_sel:[0,0] op_sel_hi:[0,1]
    v_pk_mul_f32 v[72:73], v[98:99], v[96:97] op_sel:[0,0] op_sel_hi:[0,1]
    v_pk_mul_f32 v[60:61], v[58:59], v[52:53] op_sel:[0,0] op_sel_hi:[0,1]
    v_pk_mul_f32 v[90:91], v[88:89], v[82:83] op_sel:[0,0] op_sel_hi:[0,1]
    v_pk_fma_f32 v[42:43], v[68:69], v[66:67], v[42:43] op_sel:[1,1,0] op_sel_hi:[1,0,1] neg_lo:[1,0,0]
    v_pk_fma_f32 v[72:73], v[98:99], v[96:97], v[72:73] op_sel:[1,1,0] op_sel_hi:[1,0,1] neg_lo:[1,0,0]
    v_pk_fma_f32 v[60:61], v[58:59], v[52:53], v[60:61] op_sel:[1,1,0] op_sel_hi:[1,0,1] neg_lo:[1,0,0]
    v_pk_fma_f32 v[90:91], v[88:89], v[82:83], v[90:91] op_sel:[1,1,0] op_sel_hi:[1,0,1] neg_lo:[1,0,0]
    v_cvt_pk_bf16_f32 v158, v42, v43
    v_cvt_pk_bf16_f32 v159, v72, v73
    ds_write_b64 v12, v[158:159] offset:3696
    v_pk_mul_f32 v[68:69], v[42:43], v[66:67] op_sel:[0,0] op_sel_hi:[0,1]
    v_pk_mul_f32 v[98:99], v[72:73], v[96:97] op_sel:[0,0] op_sel_hi:[0,1]
    v_pk_mul_f32 v[62:63], v[58:59], v[54:55] op_sel:[0,0] op_sel_hi:[0,1]
    v_pk_mul_f32 v[92:93], v[88:89], v[84:85] op_sel:[0,0] op_sel_hi:[0,1]
    v_pk_fma_f32 v[68:69], v[42:43], v[66:67], v[68:69] op_sel:[1,1,0] op_sel_hi:[1,0,1] neg_lo:[1,0,0]
    v_pk_fma_f32 v[98:99], v[72:73], v[96:97], v[98:99] op_sel:[1,1,0] op_sel_hi:[1,0,1] neg_lo:[1,0,0]
    v_pk_fma_f32 v[62:63], v[58:59], v[54:55], v[62:63] op_sel:[1,1,0] op_sel_hi:[1,0,1] neg_lo:[1,0,0]
    v_pk_fma_f32 v[92:93], v[88:89], v[84:85], v[92:93] op_sel:[1,1,0] op_sel_hi:[1,0,1] neg_lo:[1,0,0]
    v_cvt_pk_bf16_f32 v152, v68, v69
    v_cvt_pk_bf16_f32 v153, v98, v99
    ds_write_b64 v12, v[152:153] offset:4224
    v_pk_mul_f32 v[42:43], v[68:69], v[66:67] op_sel:[0,0] op_sel_hi:[0,1]
    v_pk_mul_f32 v[72:73], v[98:99], v[96:97] op_sel:[0,0] op_sel_hi:[0,1]
    v_pk_mul_f32 v[64:65], v[58:59], v[56:57] op_sel:[0,0] op_sel_hi:[0,1]
    v_pk_mul_f32 v[94:95], v[88:89], v[86:87] op_sel:[0,0] op_sel_hi:[0,1]
    v_pk_fma_f32 v[42:43], v[68:69], v[66:67], v[42:43] op_sel:[1,1,0] op_sel_hi:[1,0,1] neg_lo:[1,0,0]
    v_pk_fma_f32 v[72:73], v[98:99], v[96:97], v[72:73] op_sel:[1,1,0] op_sel_hi:[1,0,1] neg_lo:[1,0,0]
    v_pk_fma_f32 v[64:65], v[58:59], v[56:57], v[64:65] op_sel:[1,1,0] op_sel_hi:[1,0,1] neg_lo:[1,0,0]
    v_pk_fma_f32 v[94:95], v[88:89], v[86:87], v[94:95] op_sel:[1,1,0] op_sel_hi:[1,0,1] neg_lo:[1,0,0]
    v_cvt_pk_bf16_f32 v154, v42, v43
    v_cvt_pk_bf16_f32 v155, v72, v73
    ds_write_b64 v12, v[154:155] offset:4752
    v_pk_mul_f32 v[68:69], v[42:43], v[66:67] op_sel:[0,0] op_sel_hi:[0,1]
    v_pk_mul_f32 v[98:99], v[72:73], v[96:97] op_sel:[0,0] op_sel_hi:[0,1]
    v_pk_mul_f32 v[108:109], v[106:107], v[100:101] op_sel:[0,0] op_sel_hi:[0,1]
    v_pk_mul_f32 v[126:127], v[124:125], v[118:119] op_sel:[0,0] op_sel_hi:[0,1]
    v_pk_fma_f32 v[68:69], v[42:43], v[66:67], v[68:69] op_sel:[1,1,0] op_sel_hi:[1,0,1] neg_lo:[1,0,0]
    v_pk_fma_f32 v[98:99], v[72:73], v[96:97], v[98:99] op_sel:[1,1,0] op_sel_hi:[1,0,1] neg_lo:[1,0,0]
    v_pk_fma_f32 v[108:109], v[106:107], v[100:101], v[108:109] op_sel:[1,1,0] op_sel_hi:[1,0,1] neg_lo:[1,0,0]
    v_pk_fma_f32 v[126:127], v[124:125], v[118:119], v[126:127] op_sel:[1,1,0] op_sel_hi:[1,0,1] neg_lo:[1,0,0]
    v_cvt_pk_bf16_f32 v156, v68, v69
    v_cvt_pk_bf16_f32 v157, v98, v99
    ds_write_b64 v12, v[156:157] offset:5280
    v_pk_mul_f32 v[42:43], v[68:69], v[66:67] op_sel:[0,0] op_sel_hi:[0,1]
    v_pk_mul_f32 v[72:73], v[98:99], v[96:97] op_sel:[0,0] op_sel_hi:[0,1]
    v_pk_mul_f32 v[110:111], v[106:107], v[102:103] op_sel:[0,0] op_sel_hi:[0,1]
    v_pk_mul_f32 v[128:129], v[124:125], v[120:121] op_sel:[0,0] op_sel_hi:[0,1]
    v_pk_fma_f32 v[42:43], v[68:69], v[66:67], v[42:43] op_sel:[1,1,0] op_sel_hi:[1,0,1] neg_lo:[1,0,0]
    v_pk_fma_f32 v[72:73], v[98:99], v[96:97], v[72:73] op_sel:[1,1,0] op_sel_hi:[1,0,1] neg_lo:[1,0,0]
    v_pk_fma_f32 v[110:111], v[106:107], v[102:103], v[110:111] op_sel:[1,1,0] op_sel_hi:[1,0,1] neg_lo:[1,0,0]
    v_pk_fma_f32 v[128:129], v[124:125], v[120:121], v[128:129] op_sel:[1,1,0] op_sel_hi:[1,0,1] neg_lo:[1,0,0]
    v_cvt_pk_bf16_f32 v158, v42, v43
    v_cvt_pk_bf16_f32 v159, v72, v73
    ds_write_b64 v12, v[158:159] offset:5808
    v_pk_mul_f32 v[68:69], v[42:43], v[66:67] op_sel:[0,0] op_sel_hi:[0,1]
    v_pk_mul_f32 v[98:99], v[72:73], v[96:97] op_sel:[0,0] op_sel_hi:[0,1]
    v_pk_mul_f32 v[112:113], v[106:107], v[104:105] op_sel:[0,0] op_sel_hi:[0,1]
    v_pk_mul_f32 v[130:131], v[124:125], v[122:123] op_sel:[0,0] op_sel_hi:[0,1]
    v_pk_fma_f32 v[68:69], v[42:43], v[66:67], v[68:69] op_sel:[1,1,0] op_sel_hi:[1,0,1] neg_lo:[1,0,0]
    v_pk_fma_f32 v[98:99], v[72:73], v[96:97], v[98:99] op_sel:[1,1,0] op_sel_hi:[1,0,1] neg_lo:[1,0,0]
    v_pk_fma_f32 v[112:113], v[106:107], v[104:105], v[112:113] op_sel:[1,1,0] op_sel_hi:[1,0,1] neg_lo:[1,0,0]
    v_pk_fma_f32 v[130:131], v[124:125], v[122:123], v[130:131] op_sel:[1,1,0] op_sel_hi:[1,0,1] neg_lo:[1,0,0]
    v_cvt_pk_bf16_f32 v152, v68, v69
    v_cvt_pk_bf16_f32 v153, v98, v99
    ds_write_b64 v12, v[152:153] offset:6336
    v_pk_mul_f32 v[42:43], v[68:69], v[66:67] op_sel:[0,0] op_sel_hi:[0,1]
    v_pk_mul_f32 v[72:73], v[98:99], v[96:97] op_sel:[0,0] op_sel_hi:[0,1]
    v_pk_mul_f32 v[114:115], v[106:107], v[106:107] op_sel:[0,0] op_sel_hi:[0,1]
    v_pk_mul_f32 v[132:133], v[124:125], v[124:125] op_sel:[0,0] op_sel_hi:[0,1]
    v_pk_fma_f32 v[42:43], v[68:69], v[66:67], v[42:43] op_sel:[1,1,0] op_sel_hi:[1,0,1] neg_lo:[1,0,0]
    v_pk_fma_f32 v[72:73], v[98:99], v[96:97], v[72:73] op_sel:[1,1,0] op_sel_hi:[1,0,1] neg_lo:[1,0,0]
    v_pk_fma_f32 v[114:115], v[106:107], v[106:107], v[114:115] op_sel:[1,1,0] op_sel_hi:[1,0,1] neg_lo:[1,0,0]
    v_pk_fma_f32 v[132:133], v[124:125], v[124:125], v[132:133] op_sel:[1,1,0] op_sel_hi:[1,0,1] neg_lo:[1,0,0]
    v_cvt_pk_bf16_f32 v154, v42, v43
    v_cvt_pk_bf16_f32 v155, v72, v73
    ds_write_b64 v12, v[154:155] offset:6864
    v_pk_mul_f32 v[68:69], v[42:43], v[66:67] op_sel:[0,0] op_sel_hi:[0,1]
    v_pk_mul_f32 v[98:99], v[72:73], v[96:97] op_sel:[0,0] op_sel_hi:[0,1]
    v_pk_mul_f32 v[116:117], v[114:115], v[114:115] op_sel:[0,0] op_sel_hi:[0,1]
    v_pk_mul_f32 v[134:135], v[132:133], v[132:133] op_sel:[0,0] op_sel_hi:[0,1]
    v_pk_fma_f32 v[68:69], v[42:43], v[66:67], v[68:69] op_sel:[1,1,0] op_sel_hi:[1,0,1] neg_lo:[1,0,0]
    v_pk_fma_f32 v[98:99], v[72:73], v[96:97], v[98:99] op_sel:[1,1,0] op_sel_hi:[1,0,1] neg_lo:[1,0,0]
    v_pk_fma_f32 v[116:117], v[114:115], v[114:115], v[116:117] op_sel:[1,1,0] op_sel_hi:[1,0,1] neg_lo:[1,0,0]
    v_pk_fma_f32 v[134:135], v[132:133], v[132:133], v[134:135] op_sel:[1,1,0] op_sel_hi:[1,0,1] neg_lo:[1,0,0]
    v_cvt_pk_bf16_f32 v156, v68, v69
    v_cvt_pk_bf16_f32 v157, v98, v99
    ds_write_b64 v12, v[156:157] offset:7392
    v_pk_mul_f32 v[42:43], v[68:69], v[66:67] op_sel:[0,0] op_sel_hi:[0,1]
    v_pk_mul_f32 v[72:73], v[98:99], v[96:97] op_sel:[0,0] op_sel_hi:[0,1]
    v_pk_fma_f32 v[42:43], v[68:69], v[66:67], v[42:43] op_sel:[1,1,0] op_sel_hi:[1,0,1] neg_lo:[1,0,0]
    v_pk_fma_f32 v[72:73], v[98:99], v[96:97], v[72:73] op_sel:[1,1,0] op_sel_hi:[1,0,1] neg_lo:[1,0,0]
    v_cvt_pk_bf16_f32 v158, v42, v43
    v_cvt_pk_bf16_f32 v159, v72, v73
    ds_write_b64 v12, v[158:159] offset:7920
    ds_read_b128 v[160:163], v13 offset:0
    ds_read_b128 v[164:167], v13 offset:16
    ds_read_b128 v[168:171], v13 offset:32
    ds_read_b128 v[172:175], v13 offset:48
    ds_read_b128 v[176:179], v13 offset:64
    ds_read_b128 v[180:183], v13 offset:80
    ds_read_b128 v[184:187], v13 offset:96
    ds_read_b128 v[188:191], v13 offset:112
    s_mov_b32 s58, 0
    s_branch L_nonc_4
L_non_2:
    global_load_dwordx2 v[252:253], v254, s[46:47] sc0 sc1
    s_waitcnt vmcnt(0)
L_nonc_4:
    s_waitcnt vmcnt(0)
    v_readfirstlane_b32 s12, v252
    v_readfirstlane_b32 s13, v253
    s_nop 0
    s_cmp_lg_u32 s12, 0
    s_cbranch_scc1 L_nond_3
    s_add_u32 s58, s58, 1
    s_cmp_ge_u32 s58, 200000
    s_cbranch_scc1 L_nond_3
    s_sleep 1
    s_branch L_non_2
L_nond_3:
    s_lshl_b32 s58, s51, 2
    s_add_u32 s58, s58, s14
    s_lshl_b32 s58, s58, 5
    s_add_u32 s58, s58, s50
    s_lshl_b32 s58, s58, 3
    s_add_u32 s58, s58, 11534336
    v_mov_b32 v11, s58
    v_mov_b32 v252, s12
    v_mov_b32 v253, s13
    s_mov_b64 exec, 1
    buffer_store_dwordx2 v[252:253], v11, s[4:7], 0 offen sc0 sc1
    s_mov_b64 exec, -1
    s_setprio 0
    v_mov_b32 v152, 0x3f80
    v_mov_b32 v153, 0x3f80
    ds_write_b64 v12, v[152:153] offset:0
    v_cvt_pk_bf16_f32 v154, v52, -v53
    v_cvt_pk_bf16_f32 v155, v82, -v83
    ds_write_b64 v12, v[154:155] offset:528
    v_cvt_pk_bf16_f32 v156, v54, -v55
    v_cvt_pk_bf16_f32 v157, v84, -v85
    ds_write_b64 v12, v[156:157] offset:1056
    v_cvt_pk_bf16_f32 v158, v56, -v57
    v_cvt_pk_bf16_f32 v159, v86, -v87
    ds_write_b64 v12, v[158:159] offset:1584
    v_cvt_pk_bf16_f32 v152, v58, -v59
    v_cvt_pk_bf16_f32 v153, v88, -v89
    ds_write_b64 v12, v[152:153] offset:2112
    v_cvt_pk_bf16_f32 v154, v60, -v61
    v_cvt_pk_bf16_f32 v155, v90, -v91
    ds_write_b64 v12, v[154:155] offset:2640
    v_cvt_pk_bf16_f32 v156, v62, -v63
    v_cvt_pk_bf16_f32 v157, v92, -v93
    ds_write_b64 v12, v[156:157] offset:3168
    v_cvt_pk_bf16_f32 v158, v64, -v65
    v_cvt_pk_bf16_f32 v159, v94, -v95
    ds_write_b64 v12, v[158:159] offset:3696
    v_cvt_pk_bf16_f32 v152, v100, -v101
    v_cvt_pk_bf16_f32 v153, v118, -v119
    ds_write_b64 v12, v[152:153] offset:4224
    v_pk_mul_f32 v[136:137], v[100:101], v[52:53] op_sel:[0,0] op_sel_hi:[0,1]
    v_pk_mul_f32 v[144:145], v[118:119], v[82:83] op_sel:[0,0] op_sel_hi:[0,1]
    v_pk_fma_f32 v[136:137], v[100:101], v[52:53], v[136:137] op_sel:[1,1,0] op_sel_hi:[1,0,1] neg_lo:[1,0,0]
    v_pk_fma_f32 v[144:145], v[118:119], v[82:83], v[144:145] op_sel:[1,1,0] op_sel_hi:[1,0,1] neg_lo:[1,0,0]
    v_cvt_pk_bf16_f32 v154, v136, -v137
    v_cvt_pk_bf16_f32 v155, v144, -v145
    ds_write_b64 v12, v[154:155] offset:4752
    v_pk_mul_f32 v[138:139], v[100:101], v[54:55] op_sel:[0,0] op_sel_hi:[0,1]
    v_pk_mul_f32 v[146:147], v[118:119], v[84:85] op_sel:[0,0] op_sel_hi:[0,1]
    v_pk_fma_f32 v[138:139], v[100:101], v[54:55], v[138:139] op_sel:[1,1,0] op_sel_hi:[1,0,1] neg_lo:[1,0,0]
    v_pk_fma_f32 v[146:147], v[118:119], v[84:85], v[146:147] op_sel:[1,1,0] op_sel_hi:[1,0,1] neg_lo:[1,0,0]
    v_cvt_pk_bf16_f32 v156, v138, -v139
    v_cvt_pk_bf16_f32 v157, v146, -v147
    ds_write_b64 v12, v[156:157] offset:5280
    v_pk_mul_f32 v[140:141], v[100:101], v[56:57] op_sel:[0,0] op_sel_hi:[0,1]
    v_pk_mul_f32 v[148:149], v[118:119], v[86:87] op_sel:[0,0] op_sel_hi:[0,1]
    v_pk_fma_f32 v[140:141], v[100:101], v[56:57], v[140:141] op_sel:[1,1,0] op_sel_hi:[1,0,1] neg_lo:[1,0,0]
    v_pk_fma_f32 v[148:149], v[118:119], v[86:87], v[148:149] op_sel:[1,1,0] op_sel_hi:[1,0,1] neg_lo:[1,0,0]
    v_cvt_pk_bf16_f32 v158, v140, -v141
    v_cvt_pk_bf16_f32 v159, v148, -v149
    ds_write_b64 v12, v[158:159] offset:5808
    v_pk_mul_f32 v[142:143], v[100:101], v[58:59] op_sel:[0,0] op_sel_hi:[0,1]
    v_pk_mul_f32 v[150:151], v[118:119], v[88:89] op_sel:[0,0] op_sel_hi:[0,1]
    v_pk_fma_f32 v[142:143], v[100:101], v[58:59], v[142:143] op_sel:[1,1,0] op_sel_hi:[1,0,1] neg_lo:[1,0,0]
    v_pk_fma_f32 v[150:151], v[118:119], v[88:89], v[150:151] op_sel:[1,1,0] op_sel_hi:[1,0,1] neg_lo:[1,0,0]
    v_cvt_pk_bf16_f32 v152, v142, -v143
    v_cvt_pk_bf16_f32 v153, v150, -v151
    ds_write_b64 v12, v[152:153] offset:6336
    v_pk_mul_f32 v[136:137], v[100:101], v[60:61] op_sel:[0,0] op_sel_hi:[0,1]
    v_pk_mul_f32 v[144:145], v[118:119], v[90:91] op_sel:[0,0] op_sel_hi:[0,1]
    v_pk_fma_f32 v[136:137], v[100:101], v[60:61], v[136:137] op_sel:[1,1,0] op_sel_hi:[1,0,1] neg_lo:[1,0,0]
    v_pk_fma_f32 v[144:145], v[118:119], v[90:91], v[144:145] op_sel:[1,1,0] op_sel_hi:[1,0,1] neg_lo:[1,0,0]
    v_cvt_pk_bf16_f32 v154, v136, -v137
    v_cvt_pk_bf16_f32 v155, v144, -v145
    ds_write_b64 v12, v[154:155] offset:6864
    v_pk_mul_f32 v[138:139], v[100:101], v[62:63] op_sel:[0,0] op_sel_hi:[0,1]
    v_pk_mul_f32 v[146:147], v[118:119], v[92:93] op_sel:[0,0] op_sel_hi:[0,1]
    v_pk_fma_f32 v[138:139], v[100:101], v[62:63], v[138:139] op_sel:[1,1,0] op_sel_hi:[1,0,1] neg_lo:[1,0,0]
    v_pk_fma_f32 v[146:147], v[118:119], v[92:93], v[146:147] op_sel:[1,1,0] op_sel_hi:[1,0,1] neg_lo:[1,0,0]
    v_cvt_pk_bf16_f32 v156, v138, -v139
    v_cvt_pk_bf16_f32 v157, v146, -v147
    ds_write_b64 v12, v[156:157] offset:7392
    v_pk_mul_f32 v[140:141], v[100:101], v[64:65] op_sel:[0,0] op_sel_hi:[0,1]
    v_pk_mul_f32 v[148:149], v[118:119], v[94:95] op_sel:[0,0] op_sel_hi:[0,1]
    v_pk_fma_f32 v[140:141], v[100:101], v[64:65], v[140:141] op_sel:[1,1,0] op_sel_hi:[1,0,1] neg_lo:[1,0,0]
    v_pk_fma_f32 v[148:149], v[118:119], v[94:95], v[148:149] op_sel:[1,1,0] op_sel_hi:[1,0,1] neg_lo:[1,0,0]
    v_cvt_pk_bf16_f32 v158, v140, -v141
    v_cvt_pk_bf16_f32 v159, v148, -v149
    ds_write_b64 v12, v[158:159] offset:7920
    ds_read_b128 v[192:195], v13 offset:0
    ds_read_b128 v[196:199], v13 offset:16
    ds_read_b128 v[200:203], v13 offset:32
    ds_read_b128 v[204:207], v13 offset:48
    ds_read_b128 v[208:211], v13 offset:64
    ds_read_b128 v[212:215], v13 offset:80
    ds_read_b128 v[216:219], v13 offset:96
    ds_read_b128 v[220:223], v13 offset:112
    v_cvt_pk_bf16_f32 v152, v102, -v103
    v_cvt_pk_bf16_f32 v153, v120, -v121
    ds_write_b64 v12, v[152:153] offset:0
    v_pk_mul_f32 v[142:143], v[102:103], v[54:55] op_sel:[0,0] op_sel_hi:[0,1]
    v_pk_mul_f32 v[150:151], v[120:121], v[84:85] op_sel:[0,0] op_sel_hi:[0,1]
    v_pk_fma_f32 v[142:143], v[102:103], v[54:55], v[142:143] op_sel:[1,1,0] op_sel_hi:[1,0,1] neg_lo:[1,0,0]
    v_pk_fma_f32 v[150:151], v[120:121], v[84:85], v[150:151] op_sel:[1,1,0] op_sel_hi:[1,0,1] neg_lo:[1,0,0]
    v_cvt_pk_bf16_f32 v154, v142, -v143
    v_cvt_pk_bf16_f32 v155, v150, -v151
    ds_write_b64 v12, v[154:155] offset:528
    v_pk_mul_f32 v[136:137], v[102:103], v[58:59] op_sel:[0,0] op_sel_hi:[0,1]
    v_pk_mul_f32 v[144:145], v[120:121], v[88:89] op_sel:[0,0] op_sel_hi:[0,1]
    v_pk_fma_f32 v[136:137], v[102:103], v[58:59], v[136:137] op_sel:[1,1,0] op_sel_hi:[1,0,1] neg_lo:[1,0,0]
    v_pk_fma_f32 v[144:145], v[120:121], v[88:89], v[144:145] op_sel:[1,1,0] op_sel_hi:[1,0,1] neg_lo:[1,0,0]
    v_cvt_pk_bf16_f32 v156, v136, -v137
    v_cvt_pk_bf16_f32 v157, v144, -v145
    ds_write_b64 v12, v[156:157] offset:1056
    v_pk_mul_f32 v[138:139], v[102:103], v[62:63] op_sel:[0,0] op_sel_hi:[0,1]
    v_pk_mul_f32 v[146:147], v[120:121], v[92:93] op_sel:[0,0] op_sel_hi:[0,1]
    v_pk_fma_f32 v[138:139], v[102:103], v[62:63], v[138:139] op_sel:[1,1,0] op_sel_hi:[1,0,1] neg_lo:[1,0,0]
    v_pk_fma_f32 v[146:147], v[120:121], v[92:93], v[146:147] op_sel:[1,1,0] op_sel_hi:[1,0,1] neg_lo:[1,0,0]
    v_cvt_pk_bf16_f32 v158, v138, -v139
    v_cvt_pk_bf16_f32 v159, v146, -v147
    ds_write_b64 v12, v[158:159] offset:1584
    v_cvt_pk_bf16_f32 v152, v104, -v105
    v_cvt_pk_bf16_f32 v153, v122, -v123
    ds_write_b64 v12, v[152:153] offset:2112
    v_pk_mul_f32 v[140:141], v[104:105], v[54:55] op_sel:[0,0] op_sel_hi:[0,1]
    v_pk_mul_f32 v[148:149], v[122:123], v[84:85] op_sel:[0,0] op_sel_hi:[0,1]
    v_pk_fma_f32 v[140:141], v[104:105], v[54:55], v[140:141] op_sel:[1,1,0] op_sel_hi:[1,0,1] neg_lo:[1,0,0]
    v_pk_fma_f32 v[148:149], v[122:123], v[84:85], v[148:149] op_sel:[1,1,0] op_sel_hi:[1,0,1] neg_lo:[1,0,0]
    v_cvt_pk_bf16_f32 v154, v140, -v141
    v_cvt_pk_bf16_f32 v155, v148, -v149
    ds_write_b64 v12, v[154:155] offset:2640
    v_pk_mul_f32 v[142:143], v[104:105], v[58:59] op_sel:[0,0] op_sel_hi:[0,1]
    v_pk_mul_f32 v[150:151], v[122:123], v[88:89] op_sel:[0,0] op_sel_hi:[0,1]
    v_pk_fma_f32 v[142:143], v[104:105], v[58:59], v[142:143] op_sel:[1,1,0] op_sel_hi:[1,0,1] neg_lo:[1,0,0]
    v_pk_fma_f32 v[150:151], v[122:123], v[88:89], v[150:151] op_sel:[1,1,0] op_sel_hi:[1,0,1] neg_lo:[1,0,0]
    v_cvt_pk_bf16_f32 v156, v142, -v143
    v_cvt_pk_bf16_f32 v157, v150, -v151
    ds_write_b64 v12, v[156:157] offset:3168
    v_pk_mul_f32 v[136:137], v[104:105], v[62:63] op_sel:[0,0] op_sel_hi:[0,1]
    v_pk_mul_f32 v[144:145], v[122:123], v[92:93] op_sel:[0,0] op_sel_hi:[0,1]
    v_pk_fma_f32 v[136:137], v[104:105], v[62:63], v[136:137] op_sel:[1,1,0] op_sel_hi:[1,0,1] neg_lo:[1,0,0]
    v_pk_fma_f32 v[144:145], v[122:123], v[92:93], v[144:145] op_sel:[1,1,0] op_sel_hi:[1,0,1] neg_lo:[1,0,0]
    v_cvt_pk_bf16_f32 v158, v136, -v137
    v_cvt_pk_bf16_f32 v159, v144, -v145
    ds_write_b64 v12, v[158:159] offset:3696
    v_cvt_pk_bf16_f32 v152, v106, -v107
    v_cvt_pk_bf16_f32 v153, v124, -v125
    ds_write_b64 v12, v[152:153] offset:4224
    v_pk_mul_f32 v[138:139], v[106:107], v[58:59] op_sel:[0,0] op_sel_hi:[0,1]
    v_pk_mul_f32 v[146:147], v[124:125], v[88:89] op_sel:[0,0] op_sel_hi:[0,1]
    v_pk_fma_f32 v[138:139], v[106:107], v[58:59], v[138:139] op_sel:[1,1,0] op_sel_hi:[1,0,1] neg_lo:[1,0,0]
    v_pk_fma_f32 v[146:147], v[124:125], v[88:89], v[146:147] op_sel:[1,1,0] op_sel_hi:[1,0,1] neg_lo:[1,0,0]
    v_cvt_pk_bf16_f32 v154, v138, -v139
    v_cvt_pk_bf16_f32 v155, v146, -v147
    ds_write_b64 v12, v[154:155] offset:4752
    v_cvt_pk_bf16_f32 v156, v108, -v109
    v_cvt_pk_bf16_f32 v157, v126, -v127
    ds_write_b64 v12, v[156:157] offset:5280
    v_pk_mul_f32 v[140:141], v[108:109], v[58:59] op_sel:[0,0] op_sel_hi:[0,1]
    v_pk_mul_f32 v[148:149], v[126:127], v[88:89] op_sel:[0,0] op_sel_hi:[0,1]
    v_pk_fma_f32 v[140:141], v[108:109], v[58:59], v[140:141] op_sel:[1,1,0] op_sel_hi:[1,0,1] neg_lo:[1,0,0]
    v_pk_fma_f32 v[148:149], v[126:127], v[88:89], v[148:149] op_sel:[1,1,0] op_sel_hi:[1,0,1] neg_lo:[1,0,0]
    v_cvt_pk_bf16_f32 v158, v140, -v141
    v_cvt_pk_bf16_f32 v159, v148, -v149
    ds_write_b64 v12, v[158:159] offset:5808
    s_waitcnt lgkmcnt(12)
    v_mfma_f32_16x16x32_bf16 v[232:235], v[192:195], v[160:163], 0
    v_mfma_f32_16x16x32_bf16 v[232:235], v[196:199], v[164:167], v[232:235]
    v_mfma_f32_16x16x32_bf16 v[232:235], v[200:203], v[168:171], v[232:235]
    v_mfma_f32_16x16x32_bf16 v[232:235], v[204:207], v[172:175], v[232:235]
    v_mfma_f32_16x16x32_bf16 v[232:235], v[208:211], v[176:179], v[232:235]
    v_mfma_f32_16x16x32_bf16 v[232:235], v[212:215], v[180:183], v[232:235]
    v_mfma_f32_16x16x32_bf16 v[232:235], v[216:219], v[184:187], v[232:235]
    v_mfma_f32_16x16x32_bf16 v[232:235], v[220:223], v[188:191], v[232:235]
    v_cvt_pk_bf16_f32 v152, v110, -v111
    v_cvt_pk_bf16_f32 v153, v128, -v129
    ds_write_b64 v12, v[152:153] offset:6336
    v_pk_mul_f32 v[142:143], v[110:111], v[58:59] op_sel:[0,0] op_sel_hi:[0,1]
    v_pk_mul_f32 v[150:151], v[128:129], v[88:89] op_sel:[0,0] op_sel_hi:[0,1]
    v_pk_fma_f32 v[142:143], v[110:111], v[58:59], v[142:143] op_sel:[1,1,0] op_sel_hi:[1,0,1] neg_lo:[1,0,0]
    v_pk_fma_f32 v[150:151], v[128:129], v[88:89], v[150:151] op_sel:[1,1,0] op_sel_hi:[1,0,1] neg_lo:[1,0,0]
    v_cvt_pk_bf16_f32 v154, v142, -v143
    v_cvt_pk_bf16_f32 v155, v150, -v151
    ds_write_b64 v12, v[154:155] offset:6864
    v_cvt_pk_bf16_f32 v156, v112, -v113
    v_cvt_pk_bf16_f32 v157, v130, -v131
    ds_write_b64 v12, v[156:157] offset:7392
    v_pk_mul_f32 v[136:137], v[112:113], v[58:59] op_sel:[0,0] op_sel_hi:[0,1]
    v_pk_mul_f32 v[144:145], v[130:131], v[88:89] op_sel:[0,0] op_sel_hi:[0,1]
    v_pk_fma_f32 v[136:137], v[112:113], v[58:59], v[136:137] op_sel:[1,1,0] op_sel_hi:[1,0,1] neg_lo:[1,0,0]
    v_pk_fma_f32 v[144:145], v[130:131], v[88:89], v[144:145] op_sel:[1,1,0] op_sel_hi:[1,0,1] neg_lo:[1,0,0]
    v_cvt_pk_bf16_f32 v158, v136, -v137
    v_cvt_pk_bf16_f32 v159, v144, -v145
    ds_write_b64 v12, v[158:159] offset:7920
    ds_read_b128 v[192:195], v13 offset:0
    ds_read_b128 v[196:199], v13 offset:16
    ds_read_b128 v[200:203], v13 offset:32
    ds_read_b128 v[204:207], v13 offset:48
    ds_read_b128 v[208:211], v13 offset:64
    ds_read_b128 v[212:215], v13 offset:80
    ds_read_b128 v[216:219], v13 offset:96
    ds_read_b128 v[220:223], v13 offset:112
    v_cvt_pk_bf16_f32 v152, v114, -v115
    v_cvt_pk_bf16_f32 v153, v132, -v133
    ds_write_b64 v12, v[152:153] offset:0
    v_pk_mul_f32 v[138:139], v[114:115], v[100:101] op_sel:[0,0] op_sel_hi:[0,1]
    v_pk_mul_f32 v[146:147], v[132:133], v[118:119] op_sel:[0,0] op_sel_hi:[0,1]
    v_pk_fma_f32 v[138:139], v[114:115], v[100:101], v[138:139] op_sel:[1,1,0] op_sel_hi:[1,0,1] neg_lo:[1,0,0]
    v_pk_fma_f32 v[146:147], v[132:133], v[118:119], v[146:147] op_sel:[1,1,0] op_sel_hi:[1,0,1] neg_lo:[1,0,0]
    v_cvt_pk_bf16_f32 v154, v138, -v139
    v_cvt_pk_bf16_f32 v155, v146, -v147
    ds_write_b64 v12, v[154:155] offset:528
    v_pk_mul_f32 v[140:141], v[114:115], v[102:103] op_sel:[0,0] op_sel_hi:[0,1]
    v_pk_mul_f32 v[148:149], v[132:133], v[120:121] op_sel:[0,0] op_sel_hi:[0,1]
    v_pk_fma_f32 v[140:141], v[114:115], v[102:103], v[140:141] op_sel:[1,1,0] op_sel_hi:[1,0,1] neg_lo:[1,0,0]
    v_pk_fma_f32 v[148:149], v[132:133], v[120:121], v[148:149] op_sel:[1,1,0] op_sel_hi:[1,0,1] neg_lo:[1,0,0]
    v_cvt_pk_bf16_f32 v156, v140, -v141
    v_cvt_pk_bf16_f32 v157, v148, -v149
    ds_write_b64 v12, v[156:157] offset:1056
    v_pk_mul_f32 v[142:143], v[114:115], v[104:105] op_sel:[0,0] op_sel_hi:[0,1]
    v_pk_mul_f32 v[150:151], v[132:133], v[122:123] op_sel:[0,0] op_sel_hi:[0,1]
    v_pk_fma_f32 v[142:143], v[114:115], v[104:105], v[142:143] op_sel:[1,1,0] op_sel_hi:[1,0,1] neg_lo:[1,0,0]
    v_pk_fma_f32 v[150:151], v[132:133], v[122:123], v[150:151] op_sel:[1,1,0] op_sel_hi:[1,0,1] neg_lo:[1,0,0]
    v_cvt_pk_bf16_f32 v158, v142, -v143
    v_cvt_pk_bf16_f32 v159, v150, -v151
    ds_write_b64 v12, v[158:159] offset:1584
    v_pk_mul_f32 v[136:137], v[114:115], v[106:107] op_sel:[0,0] op_sel_hi:[0,1]
    v_pk_mul_f32 v[144:145], v[132:133], v[124:125] op_sel:[0,0] op_sel_hi:[0,1]
    v_pk_fma_f32 v[136:137], v[114:115], v[106:107], v[136:137] op_sel:[1,1,0] op_sel_hi:[1,0,1] neg_lo:[1,0,0]
    v_pk_fma_f32 v[144:145], v[132:133], v[124:125], v[144:145] op_sel:[1,1,0] op_sel_hi:[1,0,1] neg_lo:[1,0,0]
    v_cvt_pk_bf16_f32 v152, v136, -v137
    v_cvt_pk_bf16_f32 v153, v144, -v145
    ds_write_b64 v12, v[152:153] offset:2112
    v_pk_mul_f32 v[138:139], v[114:115], v[108:109] op_sel:[0,0] op_sel_hi:[0,1]
    v_pk_mul_f32 v[146:147], v[132:133], v[126:127] op_sel:[0,0] op_sel_hi:[0,1]
    v_pk_fma_f32 v[138:139], v[114:115], v[108:109], v[138:139] op_sel:[1,1,0] op_sel_hi:[1,0,1] neg_lo:[1,0,0]
    v_pk_fma_f32 v[146:147], v[132:133], v[126:127], v[146:147] op_sel:[1,1,0] op_sel_hi:[1,0,1] neg_lo:[1,0,0]
    v_cvt_pk_bf16_f32 v154, v138, -v139
    v_cvt_pk_bf16_f32 v155, v146, -v147
    ds_write_b64 v12, v[154:155] offset:2640
    v_pk_mul_f32 v[140:141], v[114:115], v[110:111] op_sel:[0,0] op_sel_hi:[0,1]
    v_pk_mul_f32 v[148:149], v[132:133], v[128:129] op_sel:[0,0] op_sel_hi:[0,1]
    v_pk_fma_f32 v[140:141], v[114:115], v[110:111], v[140:141] op_sel:[1,1,0] op_sel_hi:[1,0,1] neg_lo:[1,0,0]
    v_pk_fma_f32 v[148:149], v[132:133], v[128:129], v[148:149] op_sel:[1,1,0] op_sel_hi:[1,0,1] neg_lo:[1,0,0]
    v_cvt_pk_bf16_f32 v156, v140, -v141
    v_cvt_pk_bf16_f32 v157, v148, -v149
    ds_write_b64 v12, v[156:157] offset:3168
    v_pk_mul_f32 v[142:143], v[114:115], v[112:113] op_sel:[0,0] op_sel_hi:[0,1]
    v_pk_mul_f32 v[150:151], v[132:133], v[130:131] op_sel:[0,0] op_sel_hi:[0,1]
    v_pk_fma_f32 v[142:143], v[114:115], v[112:113], v[142:143] op_sel:[1,1,0] op_sel_hi:[1,0,1] neg_lo:[1,0,0]
    v_pk_fma_f32 v[150:151], v[132:133], v[130:131], v[150:151] op_sel:[1,1,0] op_sel_hi:[1,0,1] neg_lo:[1,0,0]
    v_cvt_pk_bf16_f32 v158, v142, -v143
    v_cvt_pk_bf16_f32 v159, v150, -v151
    ds_write_b64 v12, v[158:159] offset:3696
    v_cvt_pk_bf16_f32 v152, v116, -v117
    v_cvt_pk_bf16_f32 v153, v134, -v135
    ds_write_b64 v12, v[152:153] offset:4224
    s_waitcnt lgkmcnt(9)
    v_mfma_f32_16x16x32_bf16 v[236:239], v[192:195], v[160:163], 0
    v_mfma_f32_16x16x32_bf16 v[236:239], v[196:199], v[164:167], v[236:239]
    v_mfma_f32_16x16x32_bf16 v[236:239], v[200:203], v[168:171], v[236:239]
    v_mfma_f32_16x16x32_bf16 v[236:239], v[204:207], v[172:175], v[236:239]
    v_mfma_f32_16x16x32_bf16 v[236:239], v[208:211], v[176:179], v[236:239]
    v_mfma_f32_16x16x32_bf16 v[236:239], v[212:215], v[180:183], v[236:239]
    v_mfma_f32_16x16x32_bf16 v[236:239], v[216:219], v[184:187], v[236:239]
    v_mfma_f32_16x16x32_bf16 v[236:239], v[220:223], v[188:191], v[236:239]
    ds_read_b128 v[192:195], v13 offset:0
    ds_read_b128 v[196:199], v13 offset:16
    ds_read_b128 v[200:203], v13 offset:32
    ds_read_b128 v[204:207], v13 offset:48
    ds_read_b128 v[208:211], v13 offset:64
    ds_read_b128 v[212:215], v13 offset:80
    ds_read_b128 v[216:219], v13 offset:96
    ds_read_b128 v[220:223], v13 offset:112
    s_lshr_b32 s58, s2, 5
    s_bfe_u32 s59, s2, 0x20003
    s_lshl_b32 s58, s58, 2
    s_add_u32 s58, s58, s59
    s_lshl_b32 s58, s58, 8
    s_add_u32 s58, s58, 11534336
    v_and_b32 v8, 31, v1
    v_lshlrev_b32 v8, 3, v8
    v_add_u32 v8, s58, v8
    s_mov_b32 s58, 0
L_poll_5:
    buffer_load_dwordx2 v[16:17], v8, s[4:7], 0 offen sc0 sc1
    s_waitcnt vmcnt(0)
    v_cmp_eq_u64 vcc, s[12:13], v[16:17]
    s_nop 1
    s_cmp_eq_u64 vcc, exec
    s_cbranch_scc1 L_polld_6
    s_add_u32 s58, s58, 1
    s_cmp_ge_u32 s58, 200000
    s_cbranch_scc1 L_polld_6
    s_sleep 1
    s_branch L_poll_5
L_polld_6:
    s_mul_i32 s58, s2, 8256
    s_add_u32 s58, s58, 8
    v_lshlrev_b32 v8, 4, v0
    v_add_u32 v8, s58, v8
    buffer_load_dwordx4 v[40:43], v8, s[4:7], 0 offen offset:8 sc0 sc1
    buffer_load_dwordx4 v[44:47], v8, s[4:7], 0 offen offset:4 sc0 sc1
    buffer_load_dwordx4 v[48:51], v8, s[4:7], 0 offen offset:0 sc0 sc1
    v_add_u32 v9, 4128, v8
    buffer_load_dwordx4 v[52:55], v9, s[4:7], 0 offen offset:8 sc0 sc1
    buffer_load_dwordx4 v[56:59], v9, s[4:7], 0 offen offset:4 sc0 sc1
    buffer_load_dwordx4 v[60:63], v9, s[4:7], 0 offen offset:0 sc0 sc1
    v_lshrrev_b32 v14, 1, v2
    v_and_b32 v15, 1, v2
    v_lshlrev_b32 v4, 9, v14
    v_lshl_add_u32 v4, v3, 5, v4
    v_lshl_add_u32 v4, v15, 4, v4
    v_add_u32 v4, s62, v4
    v_lshlrev_b32 v5, 8, v2
    v_add_u32 v5, 1024, v5
    v_add_u32 v5, s62, v5
    v_lshl_add_u32 v6, v3, 4, v5
    v_lshl_add_u32 v7, v3, 3, v5
    v_cmp_gt_u32 vcc, 2, v2
    s_nop 1
    v_cndmask_b32 v5, v7, v6, vcc
    v_add_u32 v6, 8, v5
    v_add_u32 v7, 128, v5
    v_cndmask_b32 v6, v7, v6, vcc
    v_lshlrev_b32 v7, 8, v2
    v_lshl_add_u32 v7, v3, 2, v7
    v_add_u32 v7, 2048, v7
    v_add_u32 v7, s62, v7
    s_waitcnt lgkmcnt(0)
    v_mfma_f32_16x16x32_bf16 v[240:243], v[192:195], v[160:163], 0
    v_mfma_f32_16x16x32_bf16 v[240:243], v[196:199], v[164:167], v[240:243]
    v_mfma_f32_16x16x32_bf16 v[240:243], v[200:203], v[168:171], v[240:243]
    v_mfma_f32_16x16x32_bf16 v[240:243], v[204:207], v[172:175], v[240:243]
    v_mfma_f32_16x16x32_bf16 v[240:243], v[208:211], v[176:179], v[240:243]
    v_mfma_f32_16x16x32_bf16 v[240:243], v[212:215], v[180:183], v[240:243]
    v_mfma_f32_16x16x32_bf16 v[240:243], v[216:219], v[184:187], v[240:243]
    v_mfma_f32_16x16x32_bf16 v[240:243], v[220:223], v[188:191], v[240:243]
    ds_write_b128 v4, v[232:235]
    ds_write_b64 v5, v[236:237]
    ds_write_b64 v6, v[238:239]
    s_nop 4
    ds_write_b32 v7, v240 offset:0
    ds_write_b32 v7, v241 offset:64
    ds_write_b32 v7, v242 offset:128
    ds_write_b32 v7, v243 offset:192
    s_waitcnt lgkmcnt(0)
    s_barrier
    ds_read_b32 v64, v244 offset:0
    ds_read_b32 v65, v245 offset:0
    ds_read_b32 v66, v246 offset:0
    ds_read_b32 v67, v247 offset:0
    ds_read_b32 v68, v248 offset:0
    ds_read_b32 v69, v249 offset:0
    ds_read_b32 v70, v250 offset:0
    ds_read_b32 v71, v251 offset:0
    ds_read_b32 v72, v244 offset:8448
    ds_read_b32 v73, v245 offset:8448
    ds_read_b32 v74, v246 offset:8448
    ds_read_b32 v75, v247 offset:8448
    ds_read_b32 v76, v248 offset:8448
    ds_read_b32 v77, v249 offset:8448
    ds_read_b32 v78, v250 offset:8448
    ds_read_b32 v79, v251 offset:8448
    ds_read_b32 v80, v244 offset:16896
    ds_read_b32 v81, v245 offset:16896
    ds_read_b32 v82, v246 offset:16896
    ds_read_b32 v83, v247 offset:16896
    ds_read_b32 v84, v248 offset:16896
    ds_read_b32 v85, v249 offset:16896
    ds_read_b32 v86, v250 offset:16896
    ds_read_b32 v87, v251 offset:16896
    ds_read_b32 v88, v244 offset:25344
    ds_read_b32 v89, v245 offset:25344
    ds_read_b32 v90, v246 offset:25344
    ds_read_b32 v91, v247 offset:25344
    ds_read_b32 v92, v248 offset:25344
    ds_read_b32 v93, v249 offset:25344
    ds_read_b32 v94, v250 offset:25344
    ds_read_b32 v95, v251 offset:25344
    v_lshlrev_b32 v10, 4, v0
    v_sub_u32 v10, 6768, v10
    v_mov_b32 v96, 0
    v_mov_b32 v97, 0
    v_mov_b32 v98, 0
    v_mov_b32 v99, 0
    s_mov_b32 s58, 0xe38e38f
    v_mul_hi_u32 v11, v0, s58
    v_mul_u32_u24 v12, 18, v11
    v_sub_u32 v12, v0, v12
    v_mul_u32_u24 v11, 5056, v11
    v_lshl_add_u32 v11, v12, 4, v11
    v_lshrrev_b32 v12, 4, v12
    v_lshl_add_u32 v11, v12, 5, v11
    v_add_u32 v11, 33792, v11
    v_subrev_u32 v12, 144, v0
    v_and_b32 v13, 15, v12
    v_lshrrev_b32 v12, 4, v12
    v_mul_u32_u24 v12, 16896, v12
    v_lshl_add_u32 v12, v13, 4, v12
    v_add_u32 v12, 6784, v12
    v_cmp_gt_u32 vcc, 144, v0
    s_nop 1
    v_cndmask_b32 v11, v12, v11, vcc
    v_cmp_gt_u32 vcc, 176, v0
    s_nop 1
    s_and_saveexec_b64 s[58:59], vcc
    s_cbranch_execz L_zq_7
    ds_write_b128 v11, v[96:99]
L_zq_7:
    s_mov_b64 exec, s[58:59]
    v_lshlrev_b32 v11, 3, v0
    v_add_u32 v11, 144, v11
    v_lshrrev_b32 v12, 7, v11
    v_lshlrev_b32 v11, 1, v11
    v_lshl_add_u32 v11, v12, 5, v11
    v_add_u32 v11, 33792, v11
    s_waitcnt lgkmcnt(0)
    v_add_f32 v64, v64, v72
    v_add_f32 v65, v65, v73
    v_add_f32 v66, v66, v74
    v_add_f32 v67, v67, v75
    v_add_f32 v68, v68, v76
    v_add_f32 v69, v69, v77
    v_add_f32 v70, v70, v78
    v_add_f32 v71, v71, v79
    v_cvt_pk_bf16_f32 v100, v64, v65
    v_cvt_pk_bf16_f32 v101, v66, v67
    v_cvt_pk_bf16_f32 v102, v68, v69
    v_cvt_pk_bf16_f32 v103, v70, v71
    ds_write_b128 v10, v[100:103] offset:0
    v_add_f32 v80, v80, v88
    v_add_f32 v81, v81, v89
    v_add_f32 v82, v82, v90
    v_add_f32 v83, v83, v91
    v_add_f32 v84, v84, v92
    v_add_f32 v85, v85, v93
    v_add_f32 v86, v86, v94
    v_add_f32 v87, v87, v95
    v_cvt_pk_bf16_f32 v104, v80, v81
    v_cvt_pk_bf16_f32 v105, v82, v83
    v_cvt_pk_bf16_f32 v106, v84, v85
    v_cvt_pk_bf16_f32 v107, v86, v87
    ds_write_b128 v10, v[104:107] offset:16896
    s_waitcnt vmcnt(0)
    v_alignbit_b32 v108, v40, v44, 16
    v_alignbit_b32 v112, v44, v48, 16
    v_alignbit_b32 v109, v41, v45, 16
    v_alignbit_b32 v113, v45, v49, 16
    v_alignbit_b32 v110, v42, v46, 16
    v_alignbit_b32 v114, v46, v50, 16
    v_alignbit_b32 v111, v43, v47, 16
    v_alignbit_b32 v115, v47, v51, 16
    ds_write_b128 v11, v[40:43] offset:0
    ds_write_b128 v11, v[108:111] offset:5056
    ds_write_b128 v11, v[44:47] offset:10112
    ds_write_b128 v11, v[112:115] offset:15168
    v_alignbit_b32 v116, v52, v56, 16
    v_alignbit_b32 v120, v56, v60, 16
    v_alignbit_b32 v117, v53, v57, 16
    v_alignbit_b32 v121, v57, v61, 16
    v_alignbit_b32 v118, v54, v58, 16
    v_alignbit_b32 v122, v58, v62, 16
    v_alignbit_b32 v119, v55, v59, 16
    v_alignbit_b32 v123, v59, v63, 16
    ds_write_b128 v11, v[52:55] offset:20224
    ds_write_b128 v11, v[116:119] offset:25280
    ds_write_b128 v11, v[56:59] offset:30336
    ds_write_b128 v11, v[120:123] offset:35392
    s_lshr_b32 s58, s14, 1
    s_and_b32 s59, s14, 1
    s_mul_i32 s60, s58, 16896
    s_lshl_b32 s61, s59, 8
    s_sub_u32 s60, s60, s61
    s_add_u32 s60, s60, 3376
    v_sub_u32 v4, v2, v3
    v_lshlrev_b32 v4, 4, v4
    v_add_u32 v4, s60, v4
    v_lshrrev_b32 v5, 3, v3
    v_lshlrev_b32 v5, 7, v5
    v_lshl_add_u32 v5, v2, 3, v5
    v_and_b32 v6, 4, v3
    v_add_u32 v5, v5, v6
    s_lshl_b32 s61, s59, 7
    s_sub_u32 s61, 236, s61
    v_add_u32 v5, s61, v5
    v_and_b32 v6, 3, v3
    v_sub_u32 v6, 3, v6
    v_mul_u32_u24 v6, 5056, v6
    s_mul_i32 s61, s58, 20224
    s_add_u32 s61, s61, 33792
    v_add_u32 v6, s61, v6
    s_waitcnt lgkmcnt(0)
    s_barrier
    s_setprio 0
    v_mov_b32 v16, 0
    v_mov_b32 v17, 0
    v_mov_b32 v18, 0
    v_mov_b32 v19, 0
    v_mov_b32 v20, 0
    v_mov_b32 v21, 0
    v_mov_b32 v22, 0
    v_mov_b32 v23, 0
    v_mov_b32 v24, 0
    v_mov_b32 v25, 0
    v_mov_b32 v26, 0
    v_mov_b32 v27, 0
    v_mov_b32 v28, 0
    v_mov_b32 v29, 0
    v_mov_b32 v30, 0
    v_mov_b32 v31, 0
    v_mov_b32 v32, 0
    v_mov_b32 v33, 0
    v_mov_b32 v34, 0
    v_mov_b32 v35, 0
    v_mov_b32 v36, 0
    v_mov_b32 v37, 0
    v_mov_b32 v38, 0
    v_mov_b32 v39, 0
    v_mov_b32 v40, 0
    v_mov_b32 v41, 0
    v_mov_b32 v42, 0
    v_mov_b32 v43, 0
    v_mov_b32 v44, 0
    v_mov_b32 v45, 0
    v_mov_b32 v46, 0
    v_mov_b32 v47, 0
    v_lshrrev_b32 v7, 7, v5
    v_lshlrev_b32 v8, 1, v5
    v_lshl_add_u32 v7, v7, 5, v8
    v_add_u32 v7, v6, v7
    v_add_u32 v8, 4, v5
    v_lshrrev_b32 v9, 7, v8
    v_lshlrev_b32 v8, 1, v8
    v_lshl_add_u32 v8, v9, 5, v8
    v_add_u32 v8, v6, v8
    ds_read_b128 v[48:51], v4 offset:3584
    ds_read_b64 v[80:81], v7 offset:0
    ds_read_b64 v[82:83], v8 offset:0
    ds_read_b64 v[84:85], v7 offset:576
    ds_read_b64 v[86:87], v8 offset:576
    ds_read_b64 v[88:89], v7 offset:1152
    ds_read_b64 v[90:91], v8 offset:1152
    ds_read_b64 v[92:93], v7 offset:1728
    ds_read_b64 v[94:95], v8 offset:1728
    ds_read_b64 v[96:97], v7 offset:2304
    ds_read_b64 v[98:99], v8 offset:2304
    ds_read_b64 v[100:101], v7 offset:2880
    ds_read_b64 v[102:103], v8 offset:2880
    ds_read_b64 v[104:105], v7 offset:3456
    ds_read_b64 v[106:107], v8 offset:3456
    ds_read_b64 v[108:109], v7 offset:4032
    ds_read_b64 v[110:111], v8 offset:4032
    ds_read_b128 v[52:55], v4 offset:3072
    ds_read_b128 v[56:59], v4 offset:2560
    ds_read_b128 v[60:63], v4 offset:2048
    ds_read_b128 v[64:67], v4 offset:1536
    ds_read_b128 v[68:71], v4 offset:1024
    ds_read_b128 v[72:75], v4 offset:512
    ds_read_b128 v[76:79], v4 offset:0
    v_subrev_u32 v4, 64, v4
    v_subrev_u32 v5, 32, v5
    s_waitcnt lgkmcnt(0)
    v_mfma_f32_16x16x32_bf16 v[16:19], v[80:83], v[48:51], v[16:19]
    v_lshrrev_b32 v7, 7, v5
    v_lshlrev_b32 v8, 1, v5
    v_mfma_f32_16x16x32_bf16 v[20:23], v[84:87], v[48:51], v[20:23]
    v_lshl_add_u32 v7, v7, 5, v8
    v_add_u32 v7, v6, v7
    v_mfma_f32_16x16x32_bf16 v[24:27], v[88:91], v[48:51], v[24:27]
    v_add_u32 v8, 4, v5
    v_lshrrev_b32 v9, 7, v8
    v_mfma_f32_16x16x32_bf16 v[28:31], v[92:95], v[48:51], v[28:31]
    v_lshlrev_b32 v8, 1, v8
    v_lshl_add_u32 v8, v9, 5, v8
    v_mfma_f32_16x16x32_bf16 v[32:35], v[96:99], v[48:51], v[32:35]
    v_add_u32 v8, v6, v8
    ds_read_b128 v[112:115], v4 offset:3584
    v_mfma_f32_16x16x32_bf16 v[36:39], v[100:103], v[48:51], v[36:39]
    ds_read_b64 v[144:145], v7 offset:0
    ds_read_b64 v[146:147], v8 offset:0
    v_mfma_f32_16x16x32_bf16 v[40:43], v[104:107], v[48:51], v[40:43]
    ds_read_b64 v[148:149], v7 offset:576
    ds_read_b64 v[150:151], v8 offset:576
    v_mfma_f32_16x16x32_bf16 v[44:47], v[108:111], v[48:51], v[44:47]
    ds_read_b64 v[152:153], v7 offset:1152
    ds_read_b64 v[154:155], v8 offset:1152
    v_mfma_f32_16x16x32_bf16 v[20:23], v[80:83], v[52:55], v[20:23]
    ds_read_b64 v[156:157], v7 offset:1728
    ds_read_b64 v[158:159], v8 offset:1728
    v_mfma_f32_16x16x32_bf16 v[24:27], v[84:87], v[52:55], v[24:27]
    ds_read_b64 v[160:161], v7 offset:2304
    ds_read_b64 v[162:163], v8 offset:2304
    v_mfma_f32_16x16x32_bf16 v[28:31], v[88:91], v[52:55], v[28:31]
    ds_read_b64 v[164:165], v7 offset:2880
    ds_read_b64 v[166:167], v8 offset:2880
    v_mfma_f32_16x16x32_bf16 v[32:35], v[92:95], v[52:55], v[32:35]
    ds_read_b64 v[168:169], v7 offset:3456
    ds_read_b64 v[170:171], v8 offset:3456
    v_mfma_f32_16x16x32_bf16 v[36:39], v[96:99], v[52:55], v[36:39]
    ds_read_b64 v[172:173], v7 offset:4032
    ds_read_b64 v[174:175], v8 offset:4032
    v_mfma_f32_16x16x32_bf16 v[40:43], v[100:103], v[52:55], v[40:43]
    ds_read_b128 v[116:119], v4 offset:3072
    ds_read_b128 v[120:123], v4 offset:2560
    v_mfma_f32_16x16x32_bf16 v[44:47], v[104:107], v[52:55], v[44:47]
    ds_read_b128 v[124:127], v4 offset:2048
    ds_read_b128 v[128:131], v4 offset:1536
    v_mfma_f32_16x16x32_bf16 v[24:27], v[80:83], v[56:59], v[24:27]
    ds_read_b128 v[132:135], v4 offset:1024
    ds_read_b128 v[136:139], v4 offset:512
    v_mfma_f32_16x16x32_bf16 v[28:31], v[84:87], v[56:59], v[28:31]
    ds_read_b128 v[140:143], v4 offset:0
    v_subrev_u32 v4, 64, v4
    v_mfma_f32_16x16x32_bf16 v[32:35], v[88:91], v[56:59], v[32:35]
    v_subrev_u32 v5, 32, v5
    v_mfma_f32_16x16x32_bf16 v[36:39], v[92:95], v[56:59], v[36:39]
    v_mfma_f32_16x16x32_bf16 v[40:43], v[96:99], v[56:59], v[40:43]
    v_mfma_f32_16x16x32_bf16 v[44:47], v[100:103], v[56:59], v[44:47]
    v_mfma_f32_16x16x32_bf16 v[28:31], v[80:83], v[60:63], v[28:31]
    v_mfma_f32_16x16x32_bf16 v[32:35], v[84:87], v[60:63], v[32:35]
    v_mfma_f32_16x16x32_bf16 v[36:39], v[88:91], v[60:63], v[36:39]
    v_mfma_f32_16x16x32_bf16 v[40:43], v[92:95], v[60:63], v[40:43]
    v_mfma_f32_16x16x32_bf16 v[44:47], v[96:99], v[60:63], v[44:47]
    v_mfma_f32_16x16x32_bf16 v[32:35], v[80:83], v[64:67], v[32:35]
    v_mfma_f32_16x16x32_bf16 v[36:39], v[84:87], v[64:67], v[36:39]
    v_mfma_f32_16x16x32_bf16 v[40:43], v[88:91], v[64:67], v[40:43]
    v_mfma_f32_16x16x32_bf16 v[44:47], v[92:95], v[64:67], v[44:47]
    v_mfma_f32_16x16x32_bf16 v[36:39], v[80:83], v[68:71], v[36:39]
    v_mfma_f32_16x16x32_bf16 v[40:43], v[84:87], v[68:71], v[40:43]
    v_mfma_f32_16x16x32_bf16 v[44:47], v[88:91], v[68:71], v[44:47]
    v_mfma_f32_16x16x32_bf16 v[40:43], v[80:83], v[72:75], v[40:43]
    v_mfma_f32_16x16x32_bf16 v[44:47], v[84:87], v[72:75], v[44:47]
    v_mfma_f32_16x16x32_bf16 v[44:47], v[80:83], v[76:79], v[44:47]
    s_waitcnt lgkmcnt(0)
    v_mfma_f32_16x16x32_bf16 v[16:19], v[144:147], v[112:115], v[16:19]
    v_lshrrev_b32 v7, 7, v5
    v_lshlrev_b32 v8, 1, v5
    v_mfma_f32_16x16x32_bf16 v[20:23], v[148:151], v[112:115], v[20:23]
    v_lshl_add_u32 v7, v7, 5, v8
    v_add_u32 v7, v6, v7
    v_mfma_f32_16x16x32_bf16 v[24:27], v[152:155], v[112:115], v[24:27]
    v_add_u32 v8, 4, v5
    v_lshrrev_b32 v9, 7, v8
    v_mfma_f32_16x16x32_bf16 v[28:31], v[156:159], v[112:115], v[28:31]
    v_lshlrev_b32 v8, 1, v8
    v_lshl_add_u32 v8, v9, 5, v8
    v_mfma_f32_16x16x32_bf16 v[32:35], v[160:163], v[112:115], v[32:35]
    v_add_u32 v8, v6, v8
    ds_read_b128 v[48:51], v4 offset:3584
    v_mfma_f32_16x16x32_bf16 v[36:39], v[164:167], v[112:115], v[36:39]
    ds_read_b64 v[80:81], v7 offset:0
    ds_read_b64 v[82:83], v8 offset:0
    v_mfma_f32_16x16x32_bf16 v[40:43], v[168:171], v[112:115], v[40:43]
    ds_read_b64 v[84:85], v7 offset:576
    ds_read_b64 v[86:87], v8 offset:576
    v_mfma_f32_16x16x32_bf16 v[44:47], v[172:175], v[112:115], v[44:47]
    ds_read_b64 v[88:89], v7 offset:1152
    ds_read_b64 v[90:91], v8 offset:1152
    v_mfma_f32_16x16x32_bf16 v[20:23], v[144:147], v[116:119], v[20:23]
    ds_read_b64 v[92:93], v7 offset:1728
    ds_read_b64 v[94:95], v8 offset:1728
    v_mfma_f32_16x16x32_bf16 v[24:27], v[148:151], v[116:119], v[24:27]
    ds_read_b64 v[96:97], v7 offset:2304
    ds_read_b64 v[98:99], v8 offset:2304
    v_mfma_f32_16x16x32_bf16 v[28:31], v[152:155], v[116:119], v[28:31]
    ds_read_b64 v[100:101], v7 offset:2880
    ds_read_b64 v[102:103], v8 offset:2880
    v_mfma_f32_16x16x32_bf16 v[32:35], v[156:159], v[116:119], v[32:35]
    ds_read_b64 v[104:105], v7 offset:3456
    ds_read_b64 v[106:107], v8 offset:3456
    v_mfma_f32_16x16x32_bf16 v[36:39], v[160:163], v[116:119], v[36:39]
    ds_read_b64 v[108:109], v7 offset:4032
    ds_read_b64 v[110:111], v8 offset:4032
    v_mfma_f32_16x16x32_bf16 v[40:43], v[164:167], v[116:119], v[40:43]
    ds_read_b128 v[52:55], v4 offset:3072
    ds_read_b128 v[56:59], v4 offset:2560
    v_mfma_f32_16x16x32_bf16 v[44:47], v[168:171], v[116:119], v[44:47]
    ds_read_b128 v[60:63], v4 offset:2048
    ds_read_b128 v[64:67], v4 offset:1536
    v_mfma_f32_16x16x32_bf16 v[24:27], v[144:147], v[120:123], v[24:27]
    ds_read_b128 v[68:71], v4 offset:1024
    ds_read_b128 v[72:75], v4 offset:512
    v_mfma_f32_16x16x32_bf16 v[28:31], v[148:151], v[120:123], v[28:31]
    ds_read_b128 v[76:79], v4 offset:0
    v_subrev_u32 v4, 64, v4
    v_mfma_f32_16x16x32_bf16 v[32:35], v[152:155], v[120:123], v[32:35]
    v_subrev_u32 v5, 32, v5
    v_mfma_f32_16x16x32_bf16 v[36:39], v[156:159], v[120:123], v[36:39]
    v_mfma_f32_16x16x32_bf16 v[40:43], v[160:163], v[120:123], v[40:43]
    v_mfma_f32_16x16x32_bf16 v[44:47], v[164:167], v[120:123], v[44:47]
    v_mfma_f32_16x16x32_bf16 v[28:31], v[144:147], v[124:127], v[28:31]
    v_mfma_f32_16x16x32_bf16 v[32:35], v[148:151], v[124:127], v[32:35]
    v_mfma_f32_16x16x32_bf16 v[36:39], v[152:155], v[124:127], v[36:39]
    v_mfma_f32_16x16x32_bf16 v[40:43], v[156:159], v[124:127], v[40:43]
    v_mfma_f32_16x16x32_bf16 v[44:47], v[160:163], v[124:127], v[44:47]
    v_mfma_f32_16x16x32_bf16 v[32:35], v[144:147], v[128:131], v[32:35]
    v_mfma_f32_16x16x32_bf16 v[36:39], v[148:151], v[128:131], v[36:39]
    v_mfma_f32_16x16x32_bf16 v[40:43], v[152:155], v[128:131], v[40:43]
    v_mfma_f32_16x16x32_bf16 v[44:47], v[156:159], v[128:131], v[44:47]
    v_mfma_f32_16x16x32_bf16 v[36:39], v[144:147], v[132:135], v[36:39]
    v_mfma_f32_16x16x32_bf16 v[40:43], v[148:151], v[132:135], v[40:43]
    v_mfma_f32_16x16x32_bf16 v[44:47], v[152:155], v[132:135], v[44:47]
    v_mfma_f32_16x16x32_bf16 v[40:43], v[144:147], v[136:139], v[40:43]
    v_mfma_f32_16x16x32_bf16 v[44:47], v[148:151], v[136:139], v[44:47]
    v_mfma_f32_16x16x32_bf16 v[44:47], v[144:147], v[140:143], v[44:47]
    s_waitcnt lgkmcnt(0)
    v_mfma_f32_16x16x32_bf16 v[16:19], v[80:83], v[48:51], v[16:19]
    v_lshrrev_b32 v7, 7, v5
    v_lshlrev_b32 v8, 1, v5
    v_mfma_f32_16x16x32_bf16 v[20:23], v[84:87], v[48:51], v[20:23]
    v_lshl_add_u32 v7, v7, 5, v8
    v_add_u32 v7, v6, v7
    v_mfma_f32_16x16x32_bf16 v[24:27], v[88:91], v[48:51], v[24:27]
    v_add_u32 v8, 4, v5
    v_lshrrev_b32 v9, 7, v8
    v_mfma_f32_16x16x32_bf16 v[28:31], v[92:95], v[48:51], v[28:31]
    v_lshlrev_b32 v8, 1, v8
    v_lshl_add_u32 v8, v9, 5, v8
    v_mfma_f32_16x16x32_bf16 v[32:35], v[96:99], v[48:51], v[32:35]
    v_add_u32 v8, v6, v8
    ds_read_b128 v[112:115], v4 offset:3584
    v_mfma_f32_16x16x32_bf16 v[36:39], v[100:103], v[48:51], v[36:39]
    ds_read_b64 v[144:145], v7 offset:0
    ds_read_b64 v[146:147], v8 offset:0
    v_mfma_f32_16x16x32_bf16 v[40:43], v[104:107], v[48:51], v[40:43]
    ds_read_b64 v[148:149], v7 offset:576
    ds_read_b64 v[150:151], v8 offset:576
    v_mfma_f32_16x16x32_bf16 v[44:47], v[108:111], v[48:51], v[44:47]
    ds_read_b64 v[152:153], v7 offset:1152
    ds_read_b64 v[154:155], v8 offset:1152
    v_mfma_f32_16x16x32_bf16 v[20:23], v[80:83], v[52:55], v[20:23]
    ds_read_b64 v[156:157], v7 offset:1728
    ds_read_b64 v[158:159], v8 offset:1728
    v_mfma_f32_16x16x32_bf16 v[24:27], v[84:87], v[52:55], v[24:27]
    ds_read_b64 v[160:161], v7 offset:2304
    ds_read_b64 v[162:163], v8 offset:2304
    v_mfma_f32_16x16x32_bf16 v[28:31], v[88:91], v[52:55], v[28:31]
    ds_read_b64 v[164:165], v7 offset:2880
    ds_read_b64 v[166:167], v8 offset:2880
    v_mfma_f32_16x16x32_bf16 v[32:35], v[92:95], v[52:55], v[32:35]
    ds_read_b64 v[168:169], v7 offset:3456
    ds_read_b64 v[170:171], v8 offset:3456
    v_mfma_f32_16x16x32_bf16 v[36:39], v[96:99], v[52:55], v[36:39]
    ds_read_b64 v[172:173], v7 offset:4032
    ds_read_b64 v[174:175], v8 offset:4032
    v_mfma_f32_16x16x32_bf16 v[40:43], v[100:103], v[52:55], v[40:43]
    ds_read_b128 v[116:119], v4 offset:3072
    ds_read_b128 v[120:123], v4 offset:2560
    v_mfma_f32_16x16x32_bf16 v[44:47], v[104:107], v[52:55], v[44:47]
    ds_read_b128 v[124:127], v4 offset:2048
    ds_read_b128 v[128:131], v4 offset:1536
    v_mfma_f32_16x16x32_bf16 v[24:27], v[80:83], v[56:59], v[24:27]
    ds_read_b128 v[132:135], v4 offset:1024
    ds_read_b128 v[136:139], v4 offset:512
    v_mfma_f32_16x16x32_bf16 v[28:31], v[84:87], v[56:59], v[28:31]
    ds_read_b128 v[140:143], v4 offset:0
    v_subrev_u32 v4, 64, v4
    v_mfma_f32_16x16x32_bf16 v[32:35], v[88:91], v[56:59], v[32:35]
    v_subrev_u32 v5, 32, v5
    v_mfma_f32_16x16x32_bf16 v[36:39], v[92:95], v[56:59], v[36:39]
    v_mfma_f32_16x16x32_bf16 v[40:43], v[96:99], v[56:59], v[40:43]
    v_mfma_f32_16x16x32_bf16 v[44:47], v[100:103], v[56:59], v[44:47]
    v_mfma_f32_16x16x32_bf16 v[28:31], v[80:83], v[60:63], v[28:31]
    v_mfma_f32_16x16x32_bf16 v[32:35], v[84:87], v[60:63], v[32:35]
    v_mfma_f32_16x16x32_bf16 v[36:39], v[88:91], v[60:63], v[36:39]
    v_mfma_f32_16x16x32_bf16 v[40:43], v[92:95], v[60:63], v[40:43]
    v_mfma_f32_16x16x32_bf16 v[44:47], v[96:99], v[60:63], v[44:47]
    v_mfma_f32_16x16x32_bf16 v[32:35], v[80:83], v[64:67], v[32:35]
    v_mfma_f32_16x16x32_bf16 v[36:39], v[84:87], v[64:67], v[36:39]
    v_mfma_f32_16x16x32_bf16 v[40:43], v[88:91], v[64:67], v[40:43]
    v_mfma_f32_16x16x32_bf16 v[44:47], v[92:95], v[64:67], v[44:47]
    v_mfma_f32_16x16x32_bf16 v[36:39], v[80:83], v[68:71], v[36:39]
    v_mfma_f32_16x16x32_bf16 v[40:43], v[84:87], v[68:71], v[40:43]
    v_mfma_f32_16x16x32_bf16 v[44:47], v[88:91], v[68:71], v[44:47]
    v_mfma_f32_16x16x32_bf16 v[40:43], v[80:83], v[72:75], v[40:43]
    v_mfma_f32_16x16x32_bf16 v[44:47], v[84:87], v[72:75], v[44:47]
    v_mfma_f32_16x16x32_bf16 v[44:47], v[80:83], v[76:79], v[44:47]
    s_waitcnt lgkmcnt(0)
    v_mfma_f32_16x16x32_bf16 v[16:19], v[144:147], v[112:115], v[16:19]
    v_mfma_f32_16x16x32_bf16 v[20:23], v[148:151], v[112:115], v[20:23]
    v_mfma_f32_16x16x32_bf16 v[24:27], v[152:155], v[112:115], v[24:27]
    v_mfma_f32_16x16x32_bf16 v[28:31], v[156:159], v[112:115], v[28:31]
    v_mfma_f32_16x16x32_bf16 v[32:35], v[160:163], v[112:115], v[32:35]
    v_mfma_f32_16x16x32_bf16 v[36:39], v[164:167], v[112:115], v[36:39]
    v_mfma_f32_16x16x32_bf16 v[40:43], v[168:171], v[112:115], v[40:43]
    v_mfma_f32_16x16x32_bf16 v[44:47], v[172:175], v[112:115], v[44:47]
    v_mfma_f32_16x16x32_bf16 v[20:23], v[144:147], v[116:119], v[20:23]
    v_mfma_f32_16x16x32_bf16 v[24:27], v[148:151], v[116:119], v[24:27]
    v_mfma_f32_16x16x32_bf16 v[28:31], v[152:155], v[116:119], v[28:31]
    v_mfma_f32_16x16x32_bf16 v[32:35], v[156:159], v[116:119], v[32:35]
    v_mfma_f32_16x16x32_bf16 v[36:39], v[160:163], v[116:119], v[36:39]
    v_mfma_f32_16x16x32_bf16 v[40:43], v[164:167], v[116:119], v[40:43]
    v_mfma_f32_16x16x32_bf16 v[44:47], v[168:171], v[116:119], v[44:47]
    v_mfma_f32_16x16x32_bf16 v[24:27], v[144:147], v[120:123], v[24:27]
    v_mfma_f32_16x16x32_bf16 v[28:31], v[148:151], v[120:123], v[28:31]
    v_mfma_f32_16x16x32_bf16 v[32:35], v[152:155], v[120:123], v[32:35]
    v_mfma_f32_16x16x32_bf16 v[36:39], v[156:159], v[120:123], v[36:39]
    v_mfma_f32_16x16x32_bf16 v[40:43], v[160:163], v[120:123], v[40:43]
    v_mfma_f32_16x16x32_bf16 v[44:47], v[164:167], v[120:123], v[44:47]
    v_mfma_f32_16x16x32_bf16 v[28:31], v[144:147], v[124:127], v[28:31]
    v_mfma_f32_16x16x32_bf16 v[32:35], v[148:151], v[124:127], v[32:35]
    v_mfma_f32_16x16x32_bf16 v[36:39], v[152:155], v[124:127], v[36:39]
    v_mfma_f32_16x16x32_bf16 v[40:43], v[156:159], v[124:127], v[40:43]
    v_mfma_f32_16x16x32_bf16 v[44:47], v[160:163], v[124:127], v[44:47]
    v_mfma_f32_16x16x32_bf16 v[32:35], v[144:147], v[128:131], v[32:35]
    v_mfma_f32_16x16x32_bf16 v[36:39], v[148:151], v[128:131], v[36:39]
    v_mfma_f32_16x16x32_bf16 v[40:43], v[152:155], v[128:131], v[40:43]
    v_mfma_f32_16x16x32_bf16 v[44:47], v[156:159], v[128:131], v[44:47]
    v_mfma_f32_16x16x32_bf16 v[36:39], v[144:147], v[132:135], v[36:39]
    v_mfma_f32_16x16x32_bf16 v[40:43], v[148:151], v[132:135], v[40:43]
    v_mfma_f32_16x16x32_bf16 v[44:47], v[152:155], v[132:135], v[44:47]
    v_mfma_f32_16x16x32_bf16 v[40:43], v[144:147], v[136:139], v[40:43]
    v_mfma_f32_16x16x32_bf16 v[44:47], v[148:151], v[136:139], v[44:47]
    v_mfma_f32_16x16x32_bf16 v[44:47], v[144:147], v[140:143], v[44:47]
    s_setprio 3
    s_barrier
    v_lshrrev_b32 v14, 1, v2
    v_and_b32 v15, 1, v2
    v_lshlrev_b32 v4, 9, v14
    v_lshl_add_u32 v4, v3, 5, v4
    v_lshl_add_u32 v4, v15, 4, v4
    s_lshl_b32 s58, s14, 13
    s_add_u32 s58, s58, 33792
    v_add_u32 v4, s58, v4
    ds_write_b128 v4, v[16:19] offset:0
    ds_write_b128 v4, v[20:23] offset:1024
    ds_write_b128 v4, v[24:27] offset:2048
    ds_write_b128 v4, v[28:31] offset:3072
    ds_write_b128 v4, v[32:35] offset:4096
    ds_write_b128 v4, v[36:39] offset:5120
    ds_write_b128 v4, v[40:43] offset:6144
    ds_write_b128 v4, v[44:47] offset:7168
    s_waitcnt lgkmcnt(0)
    s_barrier
    v_lshlrev_b32 v4, 5, v0
    v_add_u32 v4, 33792, v4
    ds_read_b128 v[48:51], v4 offset:0
    ds_read_b128 v[52:55], v4 offset:16
    ds_read_b128 v[56:59], v4 offset:8192
    ds_read_b128 v[60:63], v4 offset:8208
    ds_read_b128 v[64:67], v4 offset:16384
    ds_read_b128 v[68:71], v4 offset:16400
    ds_read_b128 v[72:75], v4 offset:24576
    ds_read_b128 v[76:79], v4 offset:24592
    s_lshl_b32 s58, s2, 13
    s_add_u32 s58, s58, 2097152
    v_lshlrev_b32 v5, 5, v0
    v_add_u32 v5, s58, v5
    s_waitcnt lgkmcnt(0)
    v_add_f32 v48, v48, v56
    v_add_f32 v64, v64, v72
    v_add_f32 v49, v49, v57
    v_add_f32 v65, v65, v73
    v_add_f32 v50, v50, v58
    v_add_f32 v66, v66, v74
    v_add_f32 v51, v51, v59
    v_add_f32 v67, v67, v75
    v_add_f32 v52, v52, v60
    v_add_f32 v68, v68, v76
    v_add_f32 v53, v53, v61
    v_add_f32 v69, v69, v77
    v_add_f32 v54, v54, v62
    v_add_f32 v70, v70, v78
    v_add_f32 v55, v55, v63
    v_add_f32 v71, v71, v79
    v_cvt_pk_bf16_f32 v80, v48, v64
    v_cvt_pk_bf16_f32 v81, v49, v65
    v_cvt_pk_bf16_f32 v82, v50, v66
    v_cvt_pk_bf16_f32 v83, v51, v67
    v_cvt_pk_bf16_f32 v84, v52, v68
    v_cvt_pk_bf16_f32 v85, v53, v69
    v_cvt_pk_bf16_f32 v86, v54, v70
    v_cvt_pk_bf16_f32 v87, v55, v71
    buffer_store_dwordx4 v[80:83], v5, s[4:7], 0 offen sc0 sc1
    buffer_store_dwordx4 v[84:87], v5, s[4:7], 0 offen offset:16 sc0 sc1
    s_lshr_b32 s59, s2, 5
    s_and_b32 s60, s2, 31
    s_lshl_b32 s59, s59, 2
    s_add_u32 s59, s59, s14
    s_lshl_b32 s59, s59, 5
    s_add_u32 s59, s59, s60
    s_lshl_b32 s59, s59, 3
    s_add_u32 s59, s59, 11542528
    v_mov_b32 v6, s59
    s_waitcnt vmcnt(0)
    v_mov_b32 v8, s12
    v_mov_b32 v9, s13
    s_mov_b64 exec, 1
    buffer_store_dwordx2 v[8:9], v6, s[4:7], 0 offen sc0 sc1
    s_mov_b64 exec, -1
    s_endpgm
L_A:
    s_setprio 1
    s_sub_u32 s50, s2, 224
    s_and_b32 s51, s50, 7
    s_lshr_b32 s52, s50, 3
    s_and_b32 s53, s51, 3
    s_lshl_b32 s53, s53, 2
    s_and_b32 s54, s52, 3
    s_add_u32 s78, s53, s54
    s_lshr_b32 s53, s51, 2
    s_lshl_b32 s53, s53, 3
    s_lshr_b32 s54, s52, 2
    s_add_u32 s79, s53, s54
    s_mul_i32 s53, s52, 37
    s_lshr_b32 s53, s53, 8
    s_mul_i32 s54, s53, 7
    s_sub_u32 s83, s52, s54
    s_lshl_b32 s54, s51, 2
    s_add_u32 s82, s54, s53
    s_cmp_ge_u32 s52, 28
    s_cselect_b32 s82, 99, s82
    s_mov_b32 s64, s18
    s_mov_b32 s65, s19
    s_mov_b32 s66, 1204224
    s_mov_b32 s67, 0x00020000
    v_and_b32 v2, 31, v1
    v_lshrrev_b32 v3, 5, v1
    s_lshl_b32 s53, s78, 7
    s_lshl_b32 s54, s14, 5
    s_add_u32 s53, s53, s54
    v_and_b32 v4, 3, v1
    v_bfe_u32 v5, v1, 2, 3
    v_lshl_add_u32 v9, v4, 3, v5
    v_add_u32 v5, s53, v5
    v_mul_u32_u24 v5, 896, v5
    v_lshl_add_u32 v5, v3, 6, v5
    v_lshl_add_u32 v5, v4, 4, v5
    v_add_u32 v4, s53, v9
    v_add_u32 v140, 7168, v5
    v_add_u32 v141, 14336, v5
    v_add_u32 v142, 21504, v5
    v_lshrrev_b32 v6, 2, v1
    v_and_b32 v7, 3, v1
    v_mul_u32_u24 v8, 2688, v6
    v_lshl_add_u32 v8, v7, 4, v8
    s_mul_i32 s53, s79, 56
    v_add_u32 v8, s53, v8
    s_mul_i32 s55, s14, 43008
    s_lshl_b32 s56, s14, 10
    s_mul_i32 s63, s52, 37
    s_lshr_b32 s63, s63, 8
    s_mul_i32 s63, s63, 7
    s_sub_u32 s63, s52, s63
    s_mov_b32 s62, s63
    s_mov_b32 s68, s16
    s_mov_b32 s69, s17
    s_mov_b32 s70, 1835008
    s_mov_b32 s71, 0x00020000
    s_lshl_b32 s57, s62, 7
    buffer_load_dwordx4 v[144:147], v5, s[68:71], s57 offen
    buffer_load_dwordx4 v[148:151], v140, s[68:71], s57 offen
    buffer_load_dwordx4 v[152:155], v141, s[68:71], s57 offen
    buffer_load_dwordx4 v[156:159], v142, s[68:71], s57 offen
    s_mul_i32 s58, s62, 172032
    s_add_u32 s58, s58, s55
    s_add_u32 s57, s58, 896
    s_add_u32 m0, s56, 0
    s_add_u32 s58, s58, 1792
    buffer_load_dwordx4 v8, s[64:67], s57 offen lds
    s_add_u32 m0, s56, 28672
    s_add_u32 s62, s62, 1
    s_cmp_eq_u32 s62, 7
    s_cselect_b32 s62, 0, s62
    buffer_load_dwordx4 v8, s[64:67], s58 offen lds
    s_lshl_b32 s57, s62, 7
    buffer_load_dwordx4 v[160:163], v5, s[68:71], s57 offen
    buffer_load_dwordx4 v[164:167], v140, s[68:71], s57 offen
    buffer_load_dwordx4 v[168:171], v141, s[68:71], s57 offen
    buffer_load_dwordx4 v[172:175], v142, s[68:71], s57 offen
    s_mul_i32 s58, s62, 172032
    s_add_u32 s58, s58, s55
    s_add_u32 s57, s58, 896
    s_add_u32 m0, s56, 4096
    s_add_u32 s58, s58, 1792
    buffer_load_dwordx4 v8, s[64:67], s57 offen lds
    s_add_u32 m0, s56, 32768
    s_add_u32 s62, s62, 1
    s_cmp_eq_u32 s62, 7
    s_cselect_b32 s62, 0, s62
    buffer_load_dwordx4 v8, s[64:67], s58 offen lds
    s_lshl_b32 s57, s62, 7
    buffer_load_dwordx4 v[176:179], v5, s[68:71], s57 offen
    buffer_load_dwordx4 v[180:183], v140, s[68:71], s57 offen
    buffer_load_dwordx4 v[184:187], v141, s[68:71], s57 offen
    buffer_load_dwordx4 v[188:191], v142, s[68:71], s57 offen
    s_mul_i32 s58, s62, 172032
    s_add_u32 s58, s58, s55
    s_add_u32 s57, s58, 896
    s_add_u32 m0, s56, 8192
    s_add_u32 s58, s58, 1792
    buffer_load_dwordx4 v8, s[64:67], s57 offen lds
    s_add_u32 m0, s56, 36864
    s_add_u32 s62, s62, 1
    s_cmp_eq_u32 s62, 7
    s_cselect_b32 s62, 0, s62
    buffer_load_dwordx4 v8, s[64:67], s58 offen lds
    s_mov_b32 s72, 0
    s_mov_b32 s73, -1
    s_mov_b32 s74, 0x10000000
    s_mov_b32 s75, 0x10000000
    s_mov_b32 s80, 0x3fb8aa3b
    s_mov_b32 s81, 0x3f317218
    v_lshrrev_b32 v10, 4, v1
    v_bfe_u32 v11, v1, 2, 2
    v_lshl_add_u32 v11, v3, 5, v11
    v_lshlrev_b32 v11, 6, v11
    v_and_b32 v14, 1, v10
    v_lshl_add_u32 v11, v14, 5, v11
    v_lshl_add_u32 v11, v7, 3, v11
    s_waitcnt vmcnt(12)
    s_barrier
    ds_read_b64_tr_b16 v[64:65], v11 offset:0
    ds_read_b64_tr_b16 v[66:67], v11 offset:256
    ds_read_b64_tr_b16 v[68:69], v11 offset:28672
    ds_read_b64_tr_b16 v[70:71], v11 offset:28928
    ds_read_b64_tr_b16 v[72:73], v11 offset:512
    ds_read_b64_tr_b16 v[74:75], v11 offset:768
    ds_read_b64_tr_b16 v[76:77], v11 offset:29184
    ds_read_b64_tr_b16 v[78:79], v11 offset:29440
    ds_read_b64_tr_b16 v[80:81], v11 offset:1024
    ds_read_b64_tr_b16 v[82:83], v11 offset:1280
    ds_read_b64_tr_b16 v[84:85], v11 offset:29696
    ds_read_b64_tr_b16 v[86:87], v11 offset:29952
    ds_read_b64_tr_b16 v[88:89], v11 offset:1536
    ds_read_b64_tr_b16 v[90:91], v11 offset:1792
    ds_read_b64_tr_b16 v[92:93], v11 offset:30208
    ds_read_b64_tr_b16 v[94:95], v11 offset:30464
    s_mov_b32 vcc_lo, 0x55555555
    s_mov_b32 vcc_hi, 0x55555555
    v_cndmask_b32_dpp v128, v148, v144, vcc quad_perm:[1,0,3,2] row_mask:0xf bank_mask:0xf
    v_cndmask_b32_dpp v129, v149, v145, vcc quad_perm:[1,0,3,2] row_mask:0xf bank_mask:0xf
    v_cndmask_b32_dpp v130, v150, v146, vcc quad_perm:[1,0,3,2] row_mask:0xf bank_mask:0xf
    v_cndmask_b32_dpp v131, v151, v147, vcc quad_perm:[1,0,3,2] row_mask:0xf bank_mask:0xf
    v_cndmask_b32_dpp v132, v156, v152, vcc quad_perm:[1,0,3,2] row_mask:0xf bank_mask:0xf
    v_cndmask_b32_dpp v133, v157, v153, vcc quad_perm:[1,0,3,2] row_mask:0xf bank_mask:0xf
    v_cndmask_b32_dpp v134, v158, v154, vcc quad_perm:[1,0,3,2] row_mask:0xf bank_mask:0xf
    v_cndmask_b32_dpp v135, v159, v155, vcc quad_perm:[1,0,3,2] row_mask:0xf bank_mask:0xf
    s_mov_b32 vcc_lo, 0xaaaaaaaa
    s_mov_b32 vcc_hi, 0xaaaaaaaa
    v_cndmask_b32_dpp v148, v144, v148, vcc quad_perm:[1,0,3,2] row_mask:0xf bank_mask:0xf
    v_cndmask_b32_dpp v149, v145, v149, vcc quad_perm:[1,0,3,2] row_mask:0xf bank_mask:0xf
    v_cndmask_b32_dpp v150, v146, v150, vcc quad_perm:[1,0,3,2] row_mask:0xf bank_mask:0xf
    v_cndmask_b32_dpp v151, v147, v151, vcc quad_perm:[1,0,3,2] row_mask:0xf bank_mask:0xf
    v_cndmask_b32_dpp v156, v152, v156, vcc quad_perm:[1,0,3,2] row_mask:0xf bank_mask:0xf
    v_cndmask_b32_dpp v157, v153, v157, vcc quad_perm:[1,0,3,2] row_mask:0xf bank_mask:0xf
    v_cndmask_b32_dpp v158, v154, v158, vcc quad_perm:[1,0,3,2] row_mask:0xf bank_mask:0xf
    v_cndmask_b32_dpp v159, v155, v159, vcc quad_perm:[1,0,3,2] row_mask:0xf bank_mask:0xf
    s_mov_b32 vcc_lo, 0x33333333
    s_mov_b32 vcc_hi, 0x33333333
    v_cndmask_b32_dpp v144, v132, v128, vcc quad_perm:[2,3,0,1] row_mask:0xf bank_mask:0xf
    v_cndmask_b32_dpp v145, v133, v129, vcc quad_perm:[2,3,0,1] row_mask:0xf bank_mask:0xf
    v_cndmask_b32_dpp v146, v134, v130, vcc quad_perm:[2,3,0,1] row_mask:0xf bank_mask:0xf
    v_cndmask_b32_dpp v147, v135, v131, vcc quad_perm:[2,3,0,1] row_mask:0xf bank_mask:0xf
    s_mov_b32 vcc_lo, 0xcccccccc
    s_mov_b32 vcc_hi, 0xcccccccc
    v_cndmask_b32_dpp v152, v128, v132, vcc quad_perm:[2,3,0,1] row_mask:0xf bank_mask:0xf
    v_cndmask_b32_dpp v153, v129, v133, vcc quad_perm:[2,3,0,1] row_mask:0xf bank_mask:0xf
    v_cndmask_b32_dpp v154, v130, v134, vcc quad_perm:[2,3,0,1] row_mask:0xf bank_mask:0xf
    v_cndmask_b32_dpp v155, v131, v135, vcc quad_perm:[2,3,0,1] row_mask:0xf bank_mask:0xf
    v_cndmask_b32_dpp v128, v148, v156, vcc quad_perm:[2,3,0,1] row_mask:0xf bank_mask:0xf
    v_cndmask_b32_dpp v129, v149, v157, vcc quad_perm:[2,3,0,1] row_mask:0xf bank_mask:0xf
    v_cndmask_b32_dpp v130, v150, v158, vcc quad_perm:[2,3,0,1] row_mask:0xf bank_mask:0xf
    v_cndmask_b32_dpp v131, v151, v159, vcc quad_perm:[2,3,0,1] row_mask:0xf bank_mask:0xf
    s_mov_b32 vcc_lo, 0x33333333
    s_mov_b32 vcc_hi, 0x33333333
    v_cndmask_b32_dpp v148, v156, v148, vcc quad_perm:[2,3,0,1] row_mask:0xf bank_mask:0xf
    v_cndmask_b32_dpp v149, v157, v149, vcc quad_perm:[2,3,0,1] row_mask:0xf bank_mask:0xf
    v_cndmask_b32_dpp v150, v158, v150, vcc quad_perm:[2,3,0,1] row_mask:0xf bank_mask:0xf
    v_cndmask_b32_dpp v151, v159, v151, vcc quad_perm:[2,3,0,1] row_mask:0xf bank_mask:0xf
    v_mov_b32 v156, v128
    v_mov_b32 v157, v129
    v_mov_b32 v158, v130
    v_mov_b32 v159, v131
    s_waitcnt vmcnt(6)
    s_barrier
    s_waitcnt lgkmcnt(0)
    v_mfma_f32_32x32x16_bf16 v[16:31], v[64:67], v[144:147], 0
    ds_read_b64_tr_b16 v[96:97], v11 offset:4096
    ds_read_b64_tr_b16 v[98:99], v11 offset:4352
    s_mov_b32 vcc_lo, 0x55555555
    s_mov_b32 vcc_hi, 0x55555555
    v_cndmask_b32_dpp v128, v164, v160, vcc quad_perm:[1,0,3,2] row_mask:0xf bank_mask:0xf
    v_cndmask_b32_dpp v129, v165, v161, vcc quad_perm:[1,0,3,2] row_mask:0xf bank_mask:0xf
    v_cndmask_b32_dpp v130, v166, v162, vcc quad_perm:[1,0,3,2] row_mask:0xf bank_mask:0xf
    v_cndmask_b32_dpp v131, v167, v163, vcc quad_perm:[1,0,3,2] row_mask:0xf bank_mask:0xf
    v_mfma_f32_32x32x16_bf16 v[32:47], v[144:147], v[68:71], 0
    ds_read_b64_tr_b16 v[100:101], v11 offset:32768
    ds_read_b64_tr_b16 v[102:103], v11 offset:33024
    v_cndmask_b32_dpp v132, v172, v168, vcc quad_perm:[1,0,3,2] row_mask:0xf bank_mask:0xf
    v_cndmask_b32_dpp v133, v173, v169, vcc quad_perm:[1,0,3,2] row_mask:0xf bank_mask:0xf
    v_cndmask_b32_dpp v134, v174, v170, vcc quad_perm:[1,0,3,2] row_mask:0xf bank_mask:0xf
    v_cndmask_b32_dpp v135, v175, v171, vcc quad_perm:[1,0,3,2] row_mask:0xf bank_mask:0xf
    s_mov_b32 vcc_lo, 0xaaaaaaaa
    s_mov_b32 vcc_hi, 0xaaaaaaaa
    v_mfma_f32_32x32x16_bf16 v[16:31], v[72:75], v[148:151], v[16:31]
    ds_read_b64_tr_b16 v[104:105], v11 offset:4608
    ds_read_b64_tr_b16 v[106:107], v11 offset:4864
    v_cndmask_b32_dpp v164, v160, v164, vcc quad_perm:[1,0,3,2] row_mask:0xf bank_mask:0xf
    v_cndmask_b32_dpp v165, v161, v165, vcc quad_perm:[1,0,3,2] row_mask:0xf bank_mask:0xf
    v_cndmask_b32_dpp v166, v162, v166, vcc quad_perm:[1,0,3,2] row_mask:0xf bank_mask:0xf
    v_cndmask_b32_dpp v167, v163, v167, vcc quad_perm:[1,0,3,2] row_mask:0xf bank_mask:0xf
    v_cndmask_b32_dpp v172, v168, v172, vcc quad_perm:[1,0,3,2] row_mask:0xf bank_mask:0xf
    v_cndmask_b32_dpp v173, v169, v173, vcc quad_perm:[1,0,3,2] row_mask:0xf bank_mask:0xf
    v_mfma_f32_32x32x16_bf16 v[32:47], v[148:151], v[76:79], v[32:47]
    ds_read_b64_tr_b16 v[108:109], v11 offset:33280
    ds_read_b64_tr_b16 v[110:111], v11 offset:33536
    v_cndmask_b32_dpp v174, v170, v174, vcc quad_perm:[1,0,3,2] row_mask:0xf bank_mask:0xf
    v_cndmask_b32_dpp v175, v171, v175, vcc quad_perm:[1,0,3,2] row_mask:0xf bank_mask:0xf
    s_mov_b32 vcc_lo, 0x33333333
    s_mov_b32 vcc_hi, 0x33333333
    v_cndmask_b32_dpp v160, v132, v128, vcc quad_perm:[2,3,0,1] row_mask:0xf bank_mask:0xf
    v_cndmask_b32_dpp v161, v133, v129, vcc quad_perm:[2,3,0,1] row_mask:0xf bank_mask:0xf
    v_mfma_f32_32x32x16_bf16 v[16:31], v[80:83], v[152:155], v[16:31]
    ds_read_b64_tr_b16 v[112:113], v11 offset:5120
    ds_read_b64_tr_b16 v[114:115], v11 offset:5376
    v_cndmask_b32_dpp v162, v134, v130, vcc quad_perm:[2,3,0,1] row_mask:0xf bank_mask:0xf
    v_cndmask_b32_dpp v163, v135, v131, vcc quad_perm:[2,3,0,1] row_mask:0xf bank_mask:0xf
    s_mov_b32 vcc_lo, 0xcccccccc
    s_mov_b32 vcc_hi, 0xcccccccc
    v_cndmask_b32_dpp v168, v128, v132, vcc quad_perm:[2,3,0,1] row_mask:0xf bank_mask:0xf
    v_cndmask_b32_dpp v169, v129, v133, vcc quad_perm:[2,3,0,1] row_mask:0xf bank_mask:0xf
    v_mfma_f32_32x32x16_bf16 v[32:47], v[152:155], v[84:87], v[32:47]
    ds_read_b64_tr_b16 v[116:117], v11 offset:33792
    ds_read_b64_tr_b16 v[118:119], v11 offset:34048
    v_cndmask_b32_dpp v170, v130, v134, vcc quad_perm:[2,3,0,1] row_mask:0xf bank_mask:0xf
    v_cndmask_b32_dpp v171, v131, v135, vcc quad_perm:[2,3,0,1] row_mask:0xf bank_mask:0xf
    v_cndmask_b32_dpp v128, v164, v172, vcc quad_perm:[2,3,0,1] row_mask:0xf bank_mask:0xf
    v_cndmask_b32_dpp v129, v165, v173, vcc quad_perm:[2,3,0,1] row_mask:0xf bank_mask:0xf
    v_cndmask_b32_dpp v130, v166, v174, vcc quad_perm:[2,3,0,1] row_mask:0xf bank_mask:0xf
    v_cndmask_b32_dpp v131, v167, v175, vcc quad_perm:[2,3,0,1] row_mask:0xf bank_mask:0xf
    v_mfma_f32_32x32x16_bf16 v[16:31], v[88:91], v[156:159], v[16:31]
    ds_read_b64_tr_b16 v[120:121], v11 offset:5632
    ds_read_b64_tr_b16 v[122:123], v11 offset:5888
    s_mov_b32 vcc_lo, 0x33333333
    s_mov_b32 vcc_hi, 0x33333333
    v_cndmask_b32_dpp v164, v172, v164, vcc quad_perm:[2,3,0,1] row_mask:0xf bank_mask:0xf
    v_cndmask_b32_dpp v165, v173, v165, vcc quad_perm:[2,3,0,1] row_mask:0xf bank_mask:0xf
    v_cndmask_b32_dpp v166, v174, v166, vcc quad_perm:[2,3,0,1] row_mask:0xf bank_mask:0xf
    v_cndmask_b32_dpp v167, v175, v167, vcc quad_perm:[2,3,0,1] row_mask:0xf bank_mask:0xf
    v_mfma_f32_32x32x16_bf16 v[32:47], v[156:159], v[92:95], v[32:47]
    ds_read_b64_tr_b16 v[124:125], v11 offset:34304
    ds_read_b64_tr_b16 v[126:127], v11 offset:34560
    v_mov_b32 v172, v128
    v_mov_b32 v173, v129
    v_mov_b32 v174, v130
    v_mov_b32 v175, v131
    s_lshl_b32 s57, s62, 7
    buffer_load_dwordx4 v[192:195], v5, s[68:71], s57 offen
    buffer_load_dwordx4 v[196:199], v140, s[68:71], s57 offen
    buffer_load_dwordx4 v[200:203], v141, s[68:71], s57 offen
    buffer_load_dwordx4 v[204:207], v142, s[68:71], s57 offen
    s_mul_i32 s58, s62, 172032
    s_add_u32 s58, s58, s55
    s_add_u32 s57, s58, 896
    s_add_u32 m0, s56, 12288
    s_add_u32 s58, s58, 1792
    buffer_load_dwordx4 v8, s[64:67], s57 offen lds
    s_add_u32 m0, s56, 40960
    s_add_u32 s62, s62, 1
    s_cmp_eq_u32 s62, 7
    s_cselect_b32 s62, 0, s62
    buffer_load_dwordx4 v8, s[64:67], s58 offen lds
    s_waitcnt vmcnt(6)
    s_barrier
    s_waitcnt lgkmcnt(0)
    v_mfma_f32_32x32x16_bf16 v[16:31], v[96:99], v[160:163], v[16:31]
    ds_read_b64_tr_b16 v[64:65], v11 offset:8192
    ds_read_b64_tr_b16 v[66:67], v11 offset:8448
    s_mov_b32 vcc_lo, 0x55555555
    s_mov_b32 vcc_hi, 0x55555555
    v_cndmask_b32_dpp v128, v180, v176, vcc quad_perm:[1,0,3,2] row_mask:0xf bank_mask:0xf
    v_cndmask_b32_dpp v129, v181, v177, vcc quad_perm:[1,0,3,2] row_mask:0xf bank_mask:0xf
    v_cndmask_b32_dpp v130, v182, v178, vcc quad_perm:[1,0,3,2] row_mask:0xf bank_mask:0xf
    v_cndmask_b32_dpp v131, v183, v179, vcc quad_perm:[1,0,3,2] row_mask:0xf bank_mask:0xf
    v_mfma_f32_32x32x16_bf16 v[32:47], v[160:163], v[100:103], v[32:47]
    ds_read_b64_tr_b16 v[68:69], v11 offset:36864
    ds_read_b64_tr_b16 v[70:71], v11 offset:37120
    v_cndmask_b32_dpp v132, v188, v184, vcc quad_perm:[1,0,3,2] row_mask:0xf bank_mask:0xf
    v_cndmask_b32_dpp v133, v189, v185, vcc quad_perm:[1,0,3,2] row_mask:0xf bank_mask:0xf
    v_cndmask_b32_dpp v134, v190, v186, vcc quad_perm:[1,0,3,2] row_mask:0xf bank_mask:0xf
    v_cndmask_b32_dpp v135, v191, v187, vcc quad_perm:[1,0,3,2] row_mask:0xf bank_mask:0xf
    s_mov_b32 vcc_lo, 0xaaaaaaaa
    s_mov_b32 vcc_hi, 0xaaaaaaaa
    v_mfma_f32_32x32x16_bf16 v[16:31], v[104:107], v[164:167], v[16:31]
    ds_read_b64_tr_b16 v[72:73], v11 offset:8704
    ds_read_b64_tr_b16 v[74:75], v11 offset:8960
    v_cndmask_b32_dpp v180, v176, v180, vcc quad_perm:[1,0,3,2] row_mask:0xf bank_mask:0xf
    v_cndmask_b32_dpp v181, v177, v181, vcc quad_perm:[1,0,3,2] row_mask:0xf bank_mask:0xf
    v_cndmask_b32_dpp v182, v178, v182, vcc quad_perm:[1,0,3,2] row_mask:0xf bank_mask:0xf
    v_cndmask_b32_dpp v183, v179, v183, vcc quad_perm:[1,0,3,2] row_mask:0xf bank_mask:0xf
    v_cndmask_b32_dpp v188, v184, v188, vcc quad_perm:[1,0,3,2] row_mask:0xf bank_mask:0xf
    v_cndmask_b32_dpp v189, v185, v189, vcc quad_perm:[1,0,3,2] row_mask:0xf bank_mask:0xf
    v_mfma_f32_32x32x16_bf16 v[32:47], v[164:167], v[108:111], v[32:47]
    ds_read_b64_tr_b16 v[76:77], v11 offset:37376
    ds_read_b64_tr_b16 v[78:79], v11 offset:37632
    v_cndmask_b32_dpp v190, v186, v190, vcc quad_perm:[1,0,3,2] row_mask:0xf bank_mask:0xf
    v_cndmask_b32_dpp v191, v187, v191, vcc quad_perm:[1,0,3,2] row_mask:0xf bank_mask:0xf
    s_mov_b32 vcc_lo, 0x33333333
    s_mov_b32 vcc_hi, 0x33333333
    v_cndmask_b32_dpp v176, v132, v128, vcc quad_perm:[2,3,0,1] row_mask:0xf bank_mask:0xf
    v_cndmask_b32_dpp v177, v133, v129, vcc quad_perm:[2,3,0,1] row_mask:0xf bank_mask:0xf
    v_mfma_f32_32x32x16_bf16 v[16:31], v[112:115], v[168:171], v[16:31]
    ds_read_b64_tr_b16 v[80:81], v11 offset:9216
    ds_read_b64_tr_b16 v[82:83], v11 offset:9472
    v_cndmask_b32_dpp v178, v134, v130, vcc quad_perm:[2,3,0,1] row_mask:0xf bank_mask:0xf
    v_cndmask_b32_dpp v179, v135, v131, vcc quad_perm:[2,3,0,1] row_mask:0xf bank_mask:0xf
    s_mov_b32 vcc_lo, 0xcccccccc
    s_mov_b32 vcc_hi, 0xcccccccc
    v_cndmask_b32_dpp v184, v128, v132, vcc quad_perm:[2,3,0,1] row_mask:0xf bank_mask:0xf
    v_cndmask_b32_dpp v185, v129, v133, vcc quad_perm:[2,3,0,1] row_mask:0xf bank_mask:0xf
    v_mfma_f32_32x32x16_bf16 v[32:47], v[168:171], v[116:119], v[32:47]
    ds_read_b64_tr_b16 v[84:85], v11 offset:37888
    ds_read_b64_tr_b16 v[86:87], v11 offset:38144
    v_cndmask_b32_dpp v186, v130, v134, vcc quad_perm:[2,3,0,1] row_mask:0xf bank_mask:0xf
    v_cndmask_b32_dpp v187, v131, v135, vcc quad_perm:[2,3,0,1] row_mask:0xf bank_mask:0xf
    v_cndmask_b32_dpp v128, v180, v188, vcc quad_perm:[2,3,0,1] row_mask:0xf bank_mask:0xf
    v_cndmask_b32_dpp v129, v181, v189, vcc quad_perm:[2,3,0,1] row_mask:0xf bank_mask:0xf
    v_cndmask_b32_dpp v130, v182, v190, vcc quad_perm:[2,3,0,1] row_mask:0xf bank_mask:0xf
    v_cndmask_b32_dpp v131, v183, v191, vcc quad_perm:[2,3,0,1] row_mask:0xf bank_mask:0xf
    v_mfma_f32_32x32x16_bf16 v[16:31], v[120:123], v[172:175], v[16:31]
    ds_read_b64_tr_b16 v[88:89], v11 offset:9728
    ds_read_b64_tr_b16 v[90:91], v11 offset:9984
    s_mov_b32 vcc_lo, 0x33333333
    s_mov_b32 vcc_hi, 0x33333333
    v_cndmask_b32_dpp v180, v188, v180, vcc quad_perm:[2,3,0,1] row_mask:0xf bank_mask:0xf
    v_cndmask_b32_dpp v181, v189, v181, vcc quad_perm:[2,3,0,1] row_mask:0xf bank_mask:0xf
    v_cndmask_b32_dpp v182, v190, v182, vcc quad_perm:[2,3,0,1] row_mask:0xf bank_mask:0xf
    v_cndmask_b32_dpp v183, v191, v183, vcc quad_perm:[2,3,0,1] row_mask:0xf bank_mask:0xf
    v_mfma_f32_32x32x16_bf16 v[32:47], v[172:175], v[124:127], v[32:47]
    ds_read_b64_tr_b16 v[92:93], v11 offset:38400
    ds_read_b64_tr_b16 v[94:95], v11 offset:38656
    v_mov_b32 v188, v128
    v_mov_b32 v189, v129
    v_mov_b32 v190, v130
    v_mov_b32 v191, v131
    s_lshl_b32 s57, s62, 7
    buffer_load_dwordx4 v[208:211], v5, s[68:71], s57 offen
    buffer_load_dwordx4 v[212:215], v140, s[68:71], s57 offen
    buffer_load_dwordx4 v[216:219], v141, s[68:71], s57 offen
    buffer_load_dwordx4 v[220:223], v142, s[68:71], s57 offen
    s_mul_i32 s58, s62, 172032
    s_add_u32 s58, s58, s55
    s_add_u32 s57, s58, 896
    s_add_u32 m0, s56, 16384
    s_add_u32 s58, s58, 1792
    buffer_load_dwordx4 v8, s[64:67], s57 offen lds
    s_add_u32 m0, s56, 45056
    s_add_u32 s62, s62, 1
    s_cmp_eq_u32 s62, 7
    s_cselect_b32 s62, 0, s62
    buffer_load_dwordx4 v8, s[64:67], s58 offen lds
    s_waitcnt vmcnt(6)
    s_barrier
    s_waitcnt lgkmcnt(0)
    v_mfma_f32_32x32x16_bf16 v[16:31], v[64:67], v[176:179], v[16:31]
    ds_read_b64_tr_b16 v[96:97], v11 offset:12288
    ds_read_b64_tr_b16 v[98:99], v11 offset:12544
    s_mov_b32 vcc_lo, 0x55555555
    s_mov_b32 vcc_hi, 0x55555555
    v_cndmask_b32_dpp v128, v196, v192, vcc quad_perm:[1,0,3,2] row_mask:0xf bank_mask:0xf
    v_cndmask_b32_dpp v129, v197, v193, vcc quad_perm:[1,0,3,2] row_mask:0xf bank_mask:0xf
    v_cndmask_b32_dpp v130, v198, v194, vcc quad_perm:[1,0,3,2] row_mask:0xf bank_mask:0xf
    v_cndmask_b32_dpp v131, v199, v195, vcc quad_perm:[1,0,3,2] row_mask:0xf bank_mask:0xf
    v_mfma_f32_32x32x16_bf16 v[32:47], v[176:179], v[68:71], v[32:47]
    ds_read_b64_tr_b16 v[100:101], v11 offset:40960
    ds_read_b64_tr_b16 v[102:103], v11 offset:41216
    v_cndmask_b32_dpp v132, v204, v200, vcc quad_perm:[1,0,3,2] row_mask:0xf bank_mask:0xf
    v_cndmask_b32_dpp v133, v205, v201, vcc quad_perm:[1,0,3,2] row_mask:0xf bank_mask:0xf
    v_cndmask_b32_dpp v134, v206, v202, vcc quad_perm:[1,0,3,2] row_mask:0xf bank_mask:0xf
    v_cndmask_b32_dpp v135, v207, v203, vcc quad_perm:[1,0,3,2] row_mask:0xf bank_mask:0xf
    s_mov_b32 vcc_lo, 0xaaaaaaaa
    s_mov_b32 vcc_hi, 0xaaaaaaaa
    v_mfma_f32_32x32x16_bf16 v[16:31], v[72:75], v[180:183], v[16:31]
    ds_read_b64_tr_b16 v[104:105], v11 offset:12800
    ds_read_b64_tr_b16 v[106:107], v11 offset:13056
    v_cndmask_b32_dpp v196, v192, v196, vcc quad_perm:[1,0,3,2] row_mask:0xf bank_mask:0xf
    v_cndmask_b32_dpp v197, v193, v197, vcc quad_perm:[1,0,3,2] row_mask:0xf bank_mask:0xf
    v_cndmask_b32_dpp v198, v194, v198, vcc quad_perm:[1,0,3,2] row_mask:0xf bank_mask:0xf
    v_cndmask_b32_dpp v199, v195, v199, vcc quad_perm:[1,0,3,2] row_mask:0xf bank_mask:0xf
    v_cndmask_b32_dpp v204, v200, v204, vcc quad_perm:[1,0,3,2] row_mask:0xf bank_mask:0xf
    v_cndmask_b32_dpp v205, v201, v205, vcc quad_perm:[1,0,3,2] row_mask:0xf bank_mask:0xf
    v_mfma_f32_32x32x16_bf16 v[32:47], v[180:183], v[76:79], v[32:47]
    ds_read_b64_tr_b16 v[108:109], v11 offset:41472
    ds_read_b64_tr_b16 v[110:111], v11 offset:41728
    v_cndmask_b32_dpp v206, v202, v206, vcc quad_perm:[1,0,3,2] row_mask:0xf bank_mask:0xf
    v_cndmask_b32_dpp v207, v203, v207, vcc quad_perm:[1,0,3,2] row_mask:0xf bank_mask:0xf
    s_mov_b32 vcc_lo, 0x33333333
    s_mov_b32 vcc_hi, 0x33333333
    v_cndmask_b32_dpp v192, v132, v128, vcc quad_perm:[2,3,0,1] row_mask:0xf bank_mask:0xf
    v_cndmask_b32_dpp v193, v133, v129, vcc quad_perm:[2,3,0,1] row_mask:0xf bank_mask:0xf
    v_mfma_f32_32x32x16_bf16 v[16:31], v[80:83], v[184:187], v[16:31]
    ds_read_b64_tr_b16 v[112:113], v11 offset:13312
    ds_read_b64_tr_b16 v[114:115], v11 offset:13568
    v_cndmask_b32_dpp v194, v134, v130, vcc quad_perm:[2,3,0,1] row_mask:0xf bank_mask:0xf
    v_cndmask_b32_dpp v195, v135, v131, vcc quad_perm:[2,3,0,1] row_mask:0xf bank_mask:0xf
    s_mov_b32 vcc_lo, 0xcccccccc
    s_mov_b32 vcc_hi, 0xcccccccc
    v_cndmask_b32_dpp v200, v128, v132, vcc quad_perm:[2,3,0,1] row_mask:0xf bank_mask:0xf
    v_cndmask_b32_dpp v201, v129, v133, vcc quad_perm:[2,3,0,1] row_mask:0xf bank_mask:0xf
    v_mfma_f32_32x32x16_bf16 v[32:47], v[184:187], v[84:87], v[32:47]
    ds_read_b64_tr_b16 v[116:117], v11 offset:41984
    ds_read_b64_tr_b16 v[118:119], v11 offset:42240
    v_cndmask_b32_dpp v202, v130, v134, vcc quad_perm:[2,3,0,1] row_mask:0xf bank_mask:0xf
    v_cndmask_b32_dpp v203, v131, v135, vcc quad_perm:[2,3,0,1] row_mask:0xf bank_mask:0xf
    v_cndmask_b32_dpp v128, v196, v204, vcc quad_perm:[2,3,0,1] row_mask:0xf bank_mask:0xf
    v_cndmask_b32_dpp v129, v197, v205, vcc quad_perm:[2,3,0,1] row_mask:0xf bank_mask:0xf
    v_cndmask_b32_dpp v130, v198, v206, vcc quad_perm:[2,3,0,1] row_mask:0xf bank_mask:0xf
    v_cndmask_b32_dpp v131, v199, v207, vcc quad_perm:[2,3,0,1] row_mask:0xf bank_mask:0xf
    v_mfma_f32_32x32x16_bf16 v[16:31], v[88:91], v[188:191], v[16:31]
    ds_read_b64_tr_b16 v[120:121], v11 offset:13824
    ds_read_b64_tr_b16 v[122:123], v11 offset:14080
    s_mov_b32 vcc_lo, 0x33333333
    s_mov_b32 vcc_hi, 0x33333333
    v_cndmask_b32_dpp v196, v204, v196, vcc quad_perm:[2,3,0,1] row_mask:0xf bank_mask:0xf
    v_cndmask_b32_dpp v197, v205, v197, vcc quad_perm:[2,3,0,1] row_mask:0xf bank_mask:0xf
    v_cndmask_b32_dpp v198, v206, v198, vcc quad_perm:[2,3,0,1] row_mask:0xf bank_mask:0xf
    v_cndmask_b32_dpp v199, v207, v199, vcc quad_perm:[2,3,0,1] row_mask:0xf bank_mask:0xf
    v_mfma_f32_32x32x16_bf16 v[32:47], v[188:191], v[92:95], v[32:47]
    ds_read_b64_tr_b16 v[124:125], v11 offset:42496
    ds_read_b64_tr_b16 v[126:127], v11 offset:42752
    v_mov_b32 v204, v128
    v_mov_b32 v205, v129
    v_mov_b32 v206, v130
    v_mov_b32 v207, v131
    s_lshl_b32 s57, s62, 7
    buffer_load_dwordx4 v[224:227], v5, s[68:71], s57 offen
    buffer_load_dwordx4 v[228:231], v140, s[68:71], s57 offen
    buffer_load_dwordx4 v[232:235], v141, s[68:71], s57 offen
    buffer_load_dwordx4 v[236:239], v142, s[68:71], s57 offen
    s_mul_i32 s58, s62, 172032
    s_add_u32 s58, s58, s55
    s_add_u32 s57, s58, 896
    s_add_u32 m0, s56, 20480
    s_add_u32 s58, s58, 1792
    buffer_load_dwordx4 v8, s[64:67], s57 offen lds
    s_add_u32 m0, s56, 49152
    s_add_u32 s62, s62, 1
    s_cmp_eq_u32 s62, 7
    s_cselect_b32 s62, 0, s62
    buffer_load_dwordx4 v8, s[64:67], s58 offen lds
    s_waitcnt vmcnt(6)
    s_barrier
    s_waitcnt lgkmcnt(0)
    v_mfma_f32_32x32x16_bf16 v[16:31], v[96:99], v[192:195], v[16:31]
    ds_read_b64_tr_b16 v[64:65], v11 offset:16384
    ds_read_b64_tr_b16 v[66:67], v11 offset:16640
    s_mov_b32 vcc_lo, 0x55555555
    s_mov_b32 vcc_hi, 0x55555555
    v_cndmask_b32_dpp v128, v212, v208, vcc quad_perm:[1,0,3,2] row_mask:0xf bank_mask:0xf
    v_cndmask_b32_dpp v129, v213, v209, vcc quad_perm:[1,0,3,2] row_mask:0xf bank_mask:0xf
    v_cndmask_b32_dpp v130, v214, v210, vcc quad_perm:[1,0,3,2] row_mask:0xf bank_mask:0xf
    v_cndmask_b32_dpp v131, v215, v211, vcc quad_perm:[1,0,3,2] row_mask:0xf bank_mask:0xf
    v_mfma_f32_32x32x16_bf16 v[32:47], v[192:195], v[100:103], v[32:47]
    ds_read_b64_tr_b16 v[68:69], v11 offset:45056
    ds_read_b64_tr_b16 v[70:71], v11 offset:45312
    v_cndmask_b32_dpp v132, v220, v216, vcc quad_perm:[1,0,3,2] row_mask:0xf bank_mask:0xf
    v_cndmask_b32_dpp v133, v221, v217, vcc quad_perm:[1,0,3,2] row_mask:0xf bank_mask:0xf
    v_cndmask_b32_dpp v134, v222, v218, vcc quad_perm:[1,0,3,2] row_mask:0xf bank_mask:0xf
    v_cndmask_b32_dpp v135, v223, v219, vcc quad_perm:[1,0,3,2] row_mask:0xf bank_mask:0xf
    s_mov_b32 vcc_lo, 0xaaaaaaaa
    s_mov_b32 vcc_hi, 0xaaaaaaaa
    v_mfma_f32_32x32x16_bf16 v[16:31], v[104:107], v[196:199], v[16:31]
    ds_read_b64_tr_b16 v[72:73], v11 offset:16896
    ds_read_b64_tr_b16 v[74:75], v11 offset:17152
    v_cndmask_b32_dpp v212, v208, v212, vcc quad_perm:[1,0,3,2] row_mask:0xf bank_mask:0xf
    v_cndmask_b32_dpp v213, v209, v213, vcc quad_perm:[1,0,3,2] row_mask:0xf bank_mask:0xf
    v_cndmask_b32_dpp v214, v210, v214, vcc quad_perm:[1,0,3,2] row_mask:0xf bank_mask:0xf
    v_cndmask_b32_dpp v215, v211, v215, vcc quad_perm:[1,0,3,2] row_mask:0xf bank_mask:0xf
    v_cndmask_b32_dpp v220, v216, v220, vcc quad_perm:[1,0,3,2] row_mask:0xf bank_mask:0xf
    v_cndmask_b32_dpp v221, v217, v221, vcc quad_perm:[1,0,3,2] row_mask:0xf bank_mask:0xf
    v_mfma_f32_32x32x16_bf16 v[32:47], v[196:199], v[108:111], v[32:47]
    ds_read_b64_tr_b16 v[76:77], v11 offset:45568
    ds_read_b64_tr_b16 v[78:79], v11 offset:45824
    v_cndmask_b32_dpp v222, v218, v222, vcc quad_perm:[1,0,3,2] row_mask:0xf bank_mask:0xf
    v_cndmask_b32_dpp v223, v219, v223, vcc quad_perm:[1,0,3,2] row_mask:0xf bank_mask:0xf
    s_mov_b32 vcc_lo, 0x33333333
    s_mov_b32 vcc_hi, 0x33333333
    v_cndmask_b32_dpp v208, v132, v128, vcc quad_perm:[2,3,0,1] row_mask:0xf bank_mask:0xf
    v_cndmask_b32_dpp v209, v133, v129, vcc quad_perm:[2,3,0,1] row_mask:0xf bank_mask:0xf
    v_mfma_f32_32x32x16_bf16 v[16:31], v[112:115], v[200:203], v[16:31]
    ds_read_b64_tr_b16 v[80:81], v11 offset:17408
    ds_read_b64_tr_b16 v[82:83], v11 offset:17664
    v_cndmask_b32_dpp v210, v134, v130, vcc quad_perm:[2,3,0,1] row_mask:0xf bank_mask:0xf
    v_cndmask_b32_dpp v211, v135, v131, vcc quad_perm:[2,3,0,1] row_mask:0xf bank_mask:0xf
    s_mov_b32 vcc_lo, 0xcccccccc
    s_mov_b32 vcc_hi, 0xcccccccc
    v_cndmask_b32_dpp v216, v128, v132, vcc quad_perm:[2,3,0,1] row_mask:0xf bank_mask:0xf
    v_cndmask_b32_dpp v217, v129, v133, vcc quad_perm:[2,3,0,1] row_mask:0xf bank_mask:0xf
    v_mfma_f32_32x32x16_bf16 v[32:47], v[200:203], v[116:119], v[32:47]
    ds_read_b64_tr_b16 v[84:85], v11 offset:46080
    ds_read_b64_tr_b16 v[86:87], v11 offset:46336
    v_cndmask_b32_dpp v218, v130, v134, vcc quad_perm:[2,3,0,1] row_mask:0xf bank_mask:0xf
    v_cndmask_b32_dpp v219, v131, v135, vcc quad_perm:[2,3,0,1] row_mask:0xf bank_mask:0xf
    v_cndmask_b32_dpp v128, v212, v220, vcc quad_perm:[2,3,0,1] row_mask:0xf bank_mask:0xf
    v_cndmask_b32_dpp v129, v213, v221, vcc quad_perm:[2,3,0,1] row_mask:0xf bank_mask:0xf
    v_cndmask_b32_dpp v130, v214, v222, vcc quad_perm:[2,3,0,1] row_mask:0xf bank_mask:0xf
    v_cndmask_b32_dpp v131, v215, v223, vcc quad_perm:[2,3,0,1] row_mask:0xf bank_mask:0xf
    v_mfma_f32_32x32x16_bf16 v[16:31], v[120:123], v[204:207], v[16:31]
    ds_read_b64_tr_b16 v[88:89], v11 offset:17920
    ds_read_b64_tr_b16 v[90:91], v11 offset:18176
    s_mov_b32 vcc_lo, 0x33333333
    s_mov_b32 vcc_hi, 0x33333333
    v_cndmask_b32_dpp v212, v220, v212, vcc quad_perm:[2,3,0,1] row_mask:0xf bank_mask:0xf
    v_cndmask_b32_dpp v213, v221, v213, vcc quad_perm:[2,3,0,1] row_mask:0xf bank_mask:0xf
    v_cndmask_b32_dpp v214, v222, v214, vcc quad_perm:[2,3,0,1] row_mask:0xf bank_mask:0xf
    v_cndmask_b32_dpp v215, v223, v215, vcc quad_perm:[2,3,0,1] row_mask:0xf bank_mask:0xf
    v_mfma_f32_32x32x16_bf16 v[32:47], v[204:207], v[124:127], v[32:47]
    ds_read_b64_tr_b16 v[92:93], v11 offset:46592
    ds_read_b64_tr_b16 v[94:95], v11 offset:46848
    v_mov_b32 v220, v128
    v_mov_b32 v221, v129
    v_mov_b32 v222, v130
    v_mov_b32 v223, v131
    s_lshl_b32 s57, s62, 7
    buffer_load_dwordx4 v[240:243], v5, s[68:71], s57 offen
    buffer_load_dwordx4 v[244:247], v140, s[68:71], s57 offen
    buffer_load_dwordx4 v[248:251], v141, s[68:71], s57 offen
    buffer_load_dwordx4 v[252:255], v142, s[68:71], s57 offen
    s_mul_i32 s58, s62, 172032
    s_add_u32 s58, s58, s55
    s_add_u32 s57, s58, 896
    s_add_u32 m0, s56, 24576
    s_add_u32 s58, s58, 1792
    buffer_load_dwordx4 v8, s[64:67], s57 offen lds
    s_add_u32 m0, s56, 53248
    s_add_u32 s62, s62, 1
    s_cmp_eq_u32 s62, 7
    s_cselect_b32 s62, 0, s62
    buffer_load_dwordx4 v8, s[64:67], s58 offen lds
    s_mov_b32 s68, s20
    s_mov_b32 s69, s21
    s_mov_b32 s70, 25088
    s_mov_b32 s71, 0x00020000
    s_mul_i32 s53, s79, 784
    v_mul_u32_u24 v9, 112, v3
    v_add_u32 v9, v9, v2
    v_add_u32 v9, s53, v9
    v_lshlrev_b32 v9, 1, v9
    v_cmp_lt_u32 vcc, 27, v2
    s_nop 1
    s_mov_b64 s[76:77], vcc
    v_mov_b32 v10, 0x7ffff000
    v_cndmask_b32 v9, v9, v10, vcc
    buffer_load_ushort v48, v9, s[68:71], 0 offen offset:0
    buffer_load_ushort v49, v9, s[68:71], 0 offen offset:56
    buffer_load_ushort v50, v9, s[68:71], 0 offen offset:112
    buffer_load_ushort v51, v9, s[68:71], 0 offen offset:168
    buffer_load_ushort v52, v9, s[68:71], 0 offen offset:448
    buffer_load_ushort v53, v9, s[68:71], 0 offen offset:504
    buffer_load_ushort v54, v9, s[68:71], 0 offen offset:560
    buffer_load_ushort v55, v9, s[68:71], 0 offen offset:616
    buffer_load_ushort v56, v9, s[68:71], 0 offen offset:896
    buffer_load_ushort v57, v9, s[68:71], 0 offen offset:952
    buffer_load_ushort v58, v9, s[68:71], 0 offen offset:1008
    buffer_load_ushort v59, v9, s[68:71], 0 offen offset:1064
    buffer_load_ushort v60, v9, s[68:71], 0 offen offset:1344
    buffer_load_ushort v61, v9, s[68:71], 0 offen offset:1400
    buffer_load_ushort v62, v9, s[68:71], 0 offen offset:1456
    buffer_load_ushort v63, v9, s[68:71], 0 offen offset:1512
    s_mov_b32 s84, s42
    s_mov_b32 s85, s43
    s_mov_b32 s86, 896
    s_mov_b32 s87, 0x00020000
    v_lshrrev_b32 v10, 4, v1
    v_and_b32 v14, 15, v1
    s_lshl_b32 s53, s14, 4
    v_add_u32 v14, s53, v14
    v_lshl_add_u32 v143, v10, 6, v14
    v_lshlrev_b32 v143, 1, v143
    v_add_u32 v15, s63, v10
    v_subrev_u32 v9, 7, v15
    v_cmp_gt_u32 vcc, 7, v15
    s_nop 1
    v_cndmask_b32 v15, v9, v15, vcc
    v_lshl_add_u32 v15, v15, 6, v14
    v_lshlrev_b32 v15, 1, v15
    buffer_load_ushort v12, v15, s[84:87], 0 offen
    v_add_u32 v15, s63, v10
    v_add_u32 v15, 4, v15
    v_subrev_u32 v9, 7, v15
    v_cmp_gt_u32 vcc, 7, v15
    s_nop 1
    v_cndmask_b32 v15, v9, v15, vcc
    v_lshl_add_u32 v15, v15, 6, v14
    v_lshlrev_b32 v15, 1, v15
    buffer_load_ushort v13, v15, s[84:87], 0 offen
    s_waitcnt vmcnt(24)
    s_barrier
    s_waitcnt lgkmcnt(0)
    v_mfma_f32_32x32x16_bf16 v[16:31], v[64:67], v[208:211], v[16:31]
    ds_read_b64_tr_b16 v[96:97], v11 offset:20480
    ds_read_b64_tr_b16 v[98:99], v11 offset:20736
    s_mov_b32 vcc_lo, 0x55555555
    s_mov_b32 vcc_hi, 0x55555555
    v_cndmask_b32_dpp v128, v228, v224, vcc quad_perm:[1,0,3,2] row_mask:0xf bank_mask:0xf
    v_cndmask_b32_dpp v129, v229, v225, vcc quad_perm:[1,0,3,2] row_mask:0xf bank_mask:0xf
    v_cndmask_b32_dpp v130, v230, v226, vcc quad_perm:[1,0,3,2] row_mask:0xf bank_mask:0xf
    v_cndmask_b32_dpp v131, v231, v227, vcc quad_perm:[1,0,3,2] row_mask:0xf bank_mask:0xf
    v_mfma_f32_32x32x16_bf16 v[32:47], v[208:211], v[68:71], v[32:47]
    ds_read_b64_tr_b16 v[100:101], v11 offset:49152
    ds_read_b64_tr_b16 v[102:103], v11 offset:49408
    v_cndmask_b32_dpp v132, v236, v232, vcc quad_perm:[1,0,3,2] row_mask:0xf bank_mask:0xf
    v_cndmask_b32_dpp v133, v237, v233, vcc quad_perm:[1,0,3,2] row_mask:0xf bank_mask:0xf
    v_cndmask_b32_dpp v134, v238, v234, vcc quad_perm:[1,0,3,2] row_mask:0xf bank_mask:0xf
    v_cndmask_b32_dpp v135, v239, v235, vcc quad_perm:[1,0,3,2] row_mask:0xf bank_mask:0xf
    s_mov_b32 vcc_lo, 0xaaaaaaaa
    s_mov_b32 vcc_hi, 0xaaaaaaaa
    v_mfma_f32_32x32x16_bf16 v[16:31], v[72:75], v[212:215], v[16:31]
    ds_read_b64_tr_b16 v[104:105], v11 offset:20992
    ds_read_b64_tr_b16 v[106:107], v11 offset:21248
    v_cndmask_b32_dpp v228, v224, v228, vcc quad_perm:[1,0,3,2] row_mask:0xf bank_mask:0xf
    v_cndmask_b32_dpp v229, v225, v229, vcc quad_perm:[1,0,3,2] row_mask:0xf bank_mask:0xf
    v_cndmask_b32_dpp v230, v226, v230, vcc quad_perm:[1,0,3,2] row_mask:0xf bank_mask:0xf
    v_cndmask_b32_dpp v231, v227, v231, vcc quad_perm:[1,0,3,2] row_mask:0xf bank_mask:0xf
    v_cndmask_b32_dpp v236, v232, v236, vcc quad_perm:[1,0,3,2] row_mask:0xf bank_mask:0xf
    v_cndmask_b32_dpp v237, v233, v237, vcc quad_perm:[1,0,3,2] row_mask:0xf bank_mask:0xf
    v_mfma_f32_32x32x16_bf16 v[32:47], v[212:215], v[76:79], v[32:47]
    ds_read_b64_tr_b16 v[108:109], v11 offset:49664
    ds_read_b64_tr_b16 v[110:111], v11 offset:49920
    v_cndmask_b32_dpp v238, v234, v238, vcc quad_perm:[1,0,3,2] row_mask:0xf bank_mask:0xf
    v_cndmask_b32_dpp v239, v235, v239, vcc quad_perm:[1,0,3,2] row_mask:0xf bank_mask:0xf
    s_mov_b32 vcc_lo, 0x33333333
    s_mov_b32 vcc_hi, 0x33333333
    v_cndmask_b32_dpp v224, v132, v128, vcc quad_perm:[2,3,0,1] row_mask:0xf bank_mask:0xf
    v_cndmask_b32_dpp v225, v133, v129, vcc quad_perm:[2,3,0,1] row_mask:0xf bank_mask:0xf
    v_mfma_f32_32x32x16_bf16 v[16:31], v[80:83], v[216:219], v[16:31]
    ds_read_b64_tr_b16 v[112:113], v11 offset:21504
    ds_read_b64_tr_b16 v[114:115], v11 offset:21760
    v_cndmask_b32_dpp v226, v134, v130, vcc quad_perm:[2,3,0,1] row_mask:0xf bank_mask:0xf
    v_cndmask_b32_dpp v227, v135, v131, vcc quad_perm:[2,3,0,1] row_mask:0xf bank_mask:0xf
    s_mov_b32 vcc_lo, 0xcccccccc
    s_mov_b32 vcc_hi, 0xcccccccc
    v_cndmask_b32_dpp v232, v128, v132, vcc quad_perm:[2,3,0,1] row_mask:0xf bank_mask:0xf
    v_cndmask_b32_dpp v233, v129, v133, vcc quad_perm:[2,3,0,1] row_mask:0xf bank_mask:0xf
    v_mfma_f32_32x32x16_bf16 v[32:47], v[216:219], v[84:87], v[32:47]
    ds_read_b64_tr_b16 v[116:117], v11 offset:50176
    ds_read_b64_tr_b16 v[118:119], v11 offset:50432
    v_cndmask_b32_dpp v234, v130, v134, vcc quad_perm:[2,3,0,1] row_mask:0xf bank_mask:0xf
    v_cndmask_b32_dpp v235, v131, v135, vcc quad_perm:[2,3,0,1] row_mask:0xf bank_mask:0xf
    v_cndmask_b32_dpp v128, v228, v236, vcc quad_perm:[2,3,0,1] row_mask:0xf bank_mask:0xf
    v_cndmask_b32_dpp v129, v229, v237, vcc quad_perm:[2,3,0,1] row_mask:0xf bank_mask:0xf
    v_cndmask_b32_dpp v130, v230, v238, vcc quad_perm:[2,3,0,1] row_mask:0xf bank_mask:0xf
    v_cndmask_b32_dpp v131, v231, v239, vcc quad_perm:[2,3,0,1] row_mask:0xf bank_mask:0xf
    v_mfma_f32_32x32x16_bf16 v[16:31], v[88:91], v[220:223], v[16:31]
    ds_read_b64_tr_b16 v[120:121], v11 offset:22016
    ds_read_b64_tr_b16 v[122:123], v11 offset:22272
    s_mov_b32 vcc_lo, 0x33333333
    s_mov_b32 vcc_hi, 0x33333333
    v_cndmask_b32_dpp v228, v236, v228, vcc quad_perm:[2,3,0,1] row_mask:0xf bank_mask:0xf
    v_cndmask_b32_dpp v229, v237, v229, vcc quad_perm:[2,3,0,1] row_mask:0xf bank_mask:0xf
    v_cndmask_b32_dpp v230, v238, v230, vcc quad_perm:[2,3,0,1] row_mask:0xf bank_mask:0xf
    v_cndmask_b32_dpp v231, v239, v231, vcc quad_perm:[2,3,0,1] row_mask:0xf bank_mask:0xf
    v_mfma_f32_32x32x16_bf16 v[32:47], v[220:223], v[92:95], v[32:47]
    ds_read_b64_tr_b16 v[124:125], v11 offset:50688
    ds_read_b64_tr_b16 v[126:127], v11 offset:50944
    v_mov_b32 v236, v128
    v_mov_b32 v237, v129
    v_mov_b32 v238, v130
    v_mov_b32 v239, v131
    s_mov_b32 s62, s63
    s_mul_i32 s57, s62, 172032
    s_add_u32 s57, s57, s55
    s_add_u32 m0, s56, 57344
    s_add_u32 s62, s62, 1
    s_cmp_eq_u32 s62, 7
    s_cselect_b32 s62, 0, s62
    buffer_load_dwordx4 v8, s[64:67], s57 offen lds
    s_mul_i32 s57, s62, 172032
    s_add_u32 s57, s57, s55
    s_add_u32 m0, s56, 61440
    s_add_u32 s62, s62, 1
    s_cmp_eq_u32 s62, 7
    s_cselect_b32 s62, 0, s62
    buffer_load_dwordx4 v8, s[64:67], s57 offen lds
    s_waitcnt vmcnt(20)
    s_barrier
    s_waitcnt lgkmcnt(0)
    v_mfma_f32_32x32x16_bf16 v[16:31], v[96:99], v[224:227], v[16:31]
    ds_read_b64_tr_b16 v[64:65], v11 offset:24576
    ds_read_b64_tr_b16 v[66:67], v11 offset:24832
    s_mov_b32 vcc_lo, 0x55555555
    s_mov_b32 vcc_hi, 0x55555555
    v_cndmask_b32_dpp v128, v244, v240, vcc quad_perm:[1,0,3,2] row_mask:0xf bank_mask:0xf
    v_cndmask_b32_dpp v129, v245, v241, vcc quad_perm:[1,0,3,2] row_mask:0xf bank_mask:0xf
    v_cndmask_b32_dpp v130, v246, v242, vcc quad_perm:[1,0,3,2] row_mask:0xf bank_mask:0xf
    v_cndmask_b32_dpp v131, v247, v243, vcc quad_perm:[1,0,3,2] row_mask:0xf bank_mask:0xf
    v_mfma_f32_32x32x16_bf16 v[32:47], v[224:227], v[100:103], v[32:47]
    ds_read_b64_tr_b16 v[68:69], v11 offset:53248
    ds_read_b64_tr_b16 v[70:71], v11 offset:53504
    v_cndmask_b32_dpp v132, v252, v248, vcc quad_perm:[1,0,3,2] row_mask:0xf bank_mask:0xf
    v_cndmask_b32_dpp v133, v253, v249, vcc quad_perm:[1,0,3,2] row_mask:0xf bank_mask:0xf
    v_cndmask_b32_dpp v134, v254, v250, vcc quad_perm:[1,0,3,2] row_mask:0xf bank_mask:0xf
    v_cndmask_b32_dpp v135, v255, v251, vcc quad_perm:[1,0,3,2] row_mask:0xf bank_mask:0xf
    s_mov_b32 vcc_lo, 0xaaaaaaaa
    s_mov_b32 vcc_hi, 0xaaaaaaaa
    v_mfma_f32_32x32x16_bf16 v[16:31], v[104:107], v[228:231], v[16:31]
    ds_read_b64_tr_b16 v[72:73], v11 offset:25088
    ds_read_b64_tr_b16 v[74:75], v11 offset:25344
    v_cndmask_b32_dpp v244, v240, v244, vcc quad_perm:[1,0,3,2] row_mask:0xf bank_mask:0xf
    v_cndmask_b32_dpp v245, v241, v245, vcc quad_perm:[1,0,3,2] row_mask:0xf bank_mask:0xf
    v_cndmask_b32_dpp v246, v242, v246, vcc quad_perm:[1,0,3,2] row_mask:0xf bank_mask:0xf
    v_cndmask_b32_dpp v247, v243, v247, vcc quad_perm:[1,0,3,2] row_mask:0xf bank_mask:0xf
    v_cndmask_b32_dpp v252, v248, v252, vcc quad_perm:[1,0,3,2] row_mask:0xf bank_mask:0xf
    v_cndmask_b32_dpp v253, v249, v253, vcc quad_perm:[1,0,3,2] row_mask:0xf bank_mask:0xf
    v_mfma_f32_32x32x16_bf16 v[32:47], v[228:231], v[108:111], v[32:47]
    ds_read_b64_tr_b16 v[76:77], v11 offset:53760
    ds_read_b64_tr_b16 v[78:79], v11 offset:54016
    v_cndmask_b32_dpp v254, v250, v254, vcc quad_perm:[1,0,3,2] row_mask:0xf bank_mask:0xf
    v_cndmask_b32_dpp v255, v251, v255, vcc quad_perm:[1,0,3,2] row_mask:0xf bank_mask:0xf
    s_mov_b32 vcc_lo, 0x33333333
    s_mov_b32 vcc_hi, 0x33333333
    v_cndmask_b32_dpp v240, v132, v128, vcc quad_perm:[2,3,0,1] row_mask:0xf bank_mask:0xf
    v_cndmask_b32_dpp v241, v133, v129, vcc quad_perm:[2,3,0,1] row_mask:0xf bank_mask:0xf
    v_mfma_f32_32x32x16_bf16 v[16:31], v[112:115], v[232:235], v[16:31]
    ds_read_b64_tr_b16 v[80:81], v11 offset:25600
    ds_read_b64_tr_b16 v[82:83], v11 offset:25856
    v_cndmask_b32_dpp v242, v134, v130, vcc quad_perm:[2,3,0,1] row_mask:0xf bank_mask:0xf
    v_cndmask_b32_dpp v243, v135, v131, vcc quad_perm:[2,3,0,1] row_mask:0xf bank_mask:0xf
    s_mov_b32 vcc_lo, 0xcccccccc
    s_mov_b32 vcc_hi, 0xcccccccc
    v_cndmask_b32_dpp v248, v128, v132, vcc quad_perm:[2,3,0,1] row_mask:0xf bank_mask:0xf
    v_cndmask_b32_dpp v249, v129, v133, vcc quad_perm:[2,3,0,1] row_mask:0xf bank_mask:0xf
    v_mfma_f32_32x32x16_bf16 v[32:47], v[232:235], v[116:119], v[32:47]
    ds_read_b64_tr_b16 v[84:85], v11 offset:54272
    ds_read_b64_tr_b16 v[86:87], v11 offset:54528
    v_cndmask_b32_dpp v250, v130, v134, vcc quad_perm:[2,3,0,1] row_mask:0xf bank_mask:0xf
    v_cndmask_b32_dpp v251, v131, v135, vcc quad_perm:[2,3,0,1] row_mask:0xf bank_mask:0xf
    v_cndmask_b32_dpp v128, v244, v252, vcc quad_perm:[2,3,0,1] row_mask:0xf bank_mask:0xf
    v_cndmask_b32_dpp v129, v245, v253, vcc quad_perm:[2,3,0,1] row_mask:0xf bank_mask:0xf
    v_cndmask_b32_dpp v130, v246, v254, vcc quad_perm:[2,3,0,1] row_mask:0xf bank_mask:0xf
    v_cndmask_b32_dpp v131, v247, v255, vcc quad_perm:[2,3,0,1] row_mask:0xf bank_mask:0xf
    v_mfma_f32_32x32x16_bf16 v[16:31], v[120:123], v[236:239], v[16:31]
    ds_read_b64_tr_b16 v[88:89], v11 offset:26112
    ds_read_b64_tr_b16 v[90:91], v11 offset:26368
    s_mov_b32 vcc_lo, 0x33333333
    s_mov_b32 vcc_hi, 0x33333333
    v_cndmask_b32_dpp v244, v252, v244, vcc quad_perm:[2,3,0,1] row_mask:0xf bank_mask:0xf
    v_cndmask_b32_dpp v245, v253, v245, vcc quad_perm:[2,3,0,1] row_mask:0xf bank_mask:0xf
    v_cndmask_b32_dpp v246, v254, v246, vcc quad_perm:[2,3,0,1] row_mask:0xf bank_mask:0xf
    v_cndmask_b32_dpp v247, v255, v247, vcc quad_perm:[2,3,0,1] row_mask:0xf bank_mask:0xf
    v_mfma_f32_32x32x16_bf16 v[32:47], v[236:239], v[124:127], v[32:47]
    ds_read_b64_tr_b16 v[92:93], v11 offset:54784
    ds_read_b64_tr_b16 v[94:95], v11 offset:55040
    v_mov_b32 v252, v128
    v_mov_b32 v253, v129
    v_mov_b32 v254, v130
    v_mov_b32 v255, v131
    s_mul_i32 s57, s62, 172032
    s_add_u32 s57, s57, s55
    s_add_u32 m0, s56, 65536
    s_add_u32 s62, s62, 1
    s_cmp_eq_u32 s62, 7
    s_cselect_b32 s62, 0, s62
    buffer_load_dwordx4 v8, s[64:67], s57 offen lds
    s_mul_i32 s57, s62, 172032
    s_add_u32 s57, s57, s55
    s_add_u32 m0, s56, 69632
    s_add_u32 s62, s62, 1
    s_cmp_eq_u32 s62, 7
    s_cselect_b32 s62, 0, s62
    buffer_load_dwordx4 v8, s[64:67], s57 offen lds
    s_waitcnt lgkmcnt(0)
    v_mfma_f32_32x32x16_bf16 v[16:31], v[64:67], v[240:243], v[16:31]
    v_mfma_f32_32x32x16_bf16 v[32:47], v[240:243], v[68:71], v[32:47]
    v_mfma_f32_32x32x16_bf16 v[16:31], v[72:75], v[244:247], v[16:31]
    v_mfma_f32_32x32x16_bf16 v[32:47], v[244:247], v[76:79], v[32:47]
    v_mfma_f32_32x32x16_bf16 v[16:31], v[80:83], v[248:251], v[16:31]
    v_mfma_f32_32x32x16_bf16 v[32:47], v[248:251], v[84:87], v[32:47]
    v_mfma_f32_32x32x16_bf16 v[16:31], v[88:91], v[252:255], v[16:31]
    v_mfma_f32_32x32x16_bf16 v[32:47], v[252:255], v[92:95], v[32:47]
    s_mul_i32 s57, s62, 172032
    s_add_u32 s57, s57, s55
    s_add_u32 m0, s56, 73728
    s_add_u32 s62, s62, 1
    s_cmp_eq_u32 s62, 7
    s_cselect_b32 s62, 0, s62
    buffer_load_dwordx4 v8, s[64:67], s57 offen lds
    s_mul_i32 s57, s62, 172032
    s_add_u32 s57, s57, s55
    s_add_u32 m0, s56, 77824
    s_add_u32 s62, s62, 1
    s_cmp_eq_u32 s62, 7
    s_cselect_b32 s62, 0, s62
    buffer_load_dwordx4 v8, s[64:67], s57 offen lds
    s_waitcnt vmcnt(6)
    s_setprio 2
    v_mov_b32 v94, 0
    global_load_dwordx2 v[92:93], v94, s[46:47] sc0 sc1
    v_mov_b32 v14, 0x3f803f80
    v_mov_b32 v15, 0x80008000
    v_lshl_or_b32 v64, v49, 16, v48
    v_lshl_or_b32 v65, v51, 16, v50
    v_lshl_or_b32 v66, v53, 16, v52
    v_lshl_or_b32 v67, v55, 16, v54
    v_lshl_or_b32 v68, v57, 16, v56
    v_lshl_or_b32 v69, v59, 16, v58
    v_lshl_or_b32 v70, v61, 16, v60
    v_lshl_or_b32 v71, v63, 16, v62
    v_cndmask_b32 v64, v64, 0, s[76:77]
    v_cndmask_b32 v65, v65, 0, s[76:77]
    v_cndmask_b32 v66, v66, 0, s[76:77]
    v_cndmask_b32 v67, v67, 0, s[76:77]
    v_cndmask_b32 v68, v68, 0, s[76:77]
    v_cndmask_b32 v69, v69, 0, s[76:77]
    v_cndmask_b32 v70, v70, 0, s[76:77]
    v_cndmask_b32 v71, v71, 0, s[76:77]
    v_xor_b32 v80, v15, v64
    v_xor_b32 v84, v15, v68
    v_xor_b32 v81, v15, v65
    v_xor_b32 v85, v15, v69
    v_xor_b32 v82, v15, v66
    v_xor_b32 v86, v15, v70
    v_xor_b32 v83, v15, v67
    v_xor_b32 v87, v15, v71
    v_mov_b32 v72, v68
    v_mov_b32 v76, v68
    v_mov_b32 v73, v69
    v_mov_b32 v77, v69
    v_cndmask_b32 v74, v70, 0, s[72:73]
    v_cndmask_b32 v75, v71, 0, s[72:73]
    v_cndmask_b32 v78, v70, v14, s[72:73]
    v_cndmask_b32 v79, v71, 0, s[72:73]
    v_cndmask_b32 v86, v86, 0, s[72:73]
    v_cndmask_b32 v87, v87, v14, s[72:73]
    v_cvt_pk_bf16_f32 v48, v16, v17
    v_cvt_pk_bf16_f32 v49, v18, v19
    v_cvt_pk_bf16_f32 v50, v20, v21
    v_cvt_pk_bf16_f32 v51, v22, v23
    v_cvt_pk_bf16_f32 v52, v24, v25
    v_cvt_pk_bf16_f32 v53, v26, v27
    v_cvt_pk_bf16_f32 v54, v28, v29
    v_cvt_pk_bf16_f32 v55, v30, v31
    v_cvt_pk_bf16_f32 v56, v32, v33
    v_cvt_pk_bf16_f32 v57, v34, v35
    v_cvt_pk_bf16_f32 v58, v36, v37
    v_cvt_pk_bf16_f32 v59, v38, v39
    v_cvt_pk_bf16_f32 v60, v40, v41
    v_cvt_pk_bf16_f32 v61, v42, v43
    v_cvt_pk_bf16_f32 v62, v44, v45
    v_cvt_pk_bf16_f32 v63, v46, v47
    v_mfma_f32_32x32x16_bf16 v[16:31], v[64:67], v[48:51], 0
    v_mfma_f32_32x32x16_bf16 v[16:31], v[72:75], v[52:55], v[16:31]
    v_cndmask_b32 v56, v56, v14, s[74:75]
    v_cndmask_b32 v57, v57, v14, s[74:75]
    v_cndmask_b32 v58, v58, v14, s[74:75]
    v_cndmask_b32 v59, v59, v14, s[74:75]
    v_cndmask_b32 v60, v60, v14, s[74:75]
    v_cndmask_b32 v61, v61, v14, s[74:75]
    v_cndmask_b32 v62, v62, v14, s[74:75]
    v_cndmask_b32 v63, v63, v14, s[74:75]
    s_nop 3
    v_cndmask_b32 v28, v28, v27, s[72:73]
    v_cndmask_b32 v29, v29, v27, s[72:73]
    v_cndmask_b32 v30, v30, v27, s[72:73]
    v_cndmask_b32 v31, v31, v27, s[72:73]
    v_max3_f32 v96, v16, v17, v18
    v_min3_f32 v97, v16, v17, v18
    v_max3_f32 v96, v96, v19, v20
    v_min3_f32 v97, v97, v19, v20
    v_max3_f32 v96, v96, v21, v22
    v_min3_f32 v97, v97, v21, v22
    v_max3_f32 v96, v96, v23, v24
    v_min3_f32 v97, v97, v23, v24
    v_max3_f32 v96, v96, v25, v26
    v_min3_f32 v97, v97, v25, v26
    v_max3_f32 v96, v96, v27, v28
    v_min3_f32 v97, v97, v27, v28
    v_max3_f32 v96, v96, v29, v30
    v_min3_f32 v97, v97, v29, v30
    v_max_f32 v96, v96, v31
    v_min_f32 v97, v97, v31
    v_mov_b32 v100, v96
    v_mov_b32 v101, v96
    v_mov_b32 v102, v97
    v_mov_b32 v103, v97
    v_permlane32_swap_b32 v100, v101
    s_nop 0
    v_permlane32_swap_b32 v102, v103
    v_max_f32 v96, v100, v101
    v_min_f32 v97, v102, v103
    v_mul_f32 v102, s80, v96
    v_mul_f32 v103, s80, v97
    v_fma_f32 v104, v16, s80, -v102
    v_fma_f32 v120, -v16, s80, v103
    v_fma_f32 v105, v17, s80, -v102
    v_fma_f32 v121, -v17, s80, v103
    v_fma_f32 v106, v18, s80, -v102
    v_fma_f32 v122, -v18, s80, v103
    v_fma_f32 v107, v19, s80, -v102
    v_fma_f32 v123, -v19, s80, v103
    v_fma_f32 v108, v20, s80, -v102
    v_fma_f32 v124, -v20, s80, v103
    v_fma_f32 v109, v21, s80, -v102
    v_fma_f32 v125, -v21, s80, v103
    v_fma_f32 v110, v22, s80, -v102
    v_fma_f32 v126, -v22, s80, v103
    v_fma_f32 v111, v23, s80, -v102
    v_fma_f32 v127, -v23, s80, v103
    v_fma_f32 v112, v24, s80, -v102
    v_fma_f32 v128, -v24, s80, v103
    v_fma_f32 v113, v25, s80, -v102
    v_fma_f32 v129, -v25, s80, v103
    v_fma_f32 v114, v26, s80, -v102
    v_fma_f32 v130, -v26, s80, v103
    v_fma_f32 v115, v27, s80, -v102
    v_fma_f32 v131, -v27, s80, v103
    v_fma_f32 v116, v28, s80, -v102
    v_fma_f32 v132, -v28, s80, v103
    v_fma_f32 v117, v29, s80, -v102
    v_fma_f32 v133, -v29, s80, v103
    v_fma_f32 v118, v30, s80, -v102
    v_fma_f32 v134, -v30, s80, v103
    v_fma_f32 v119, v31, s80, -v102
    v_fma_f32 v135, -v31, s80, v103
    v_exp_f32 v104, v104
    v_exp_f32 v120, v120
    v_exp_f32 v105, v105
    v_exp_f32 v121, v121
    v_exp_f32 v106, v106
    v_exp_f32 v122, v122
    v_exp_f32 v107, v107
    v_exp_f32 v123, v123
    v_exp_f32 v108, v108
    v_exp_f32 v124, v124
    v_exp_f32 v109, v109
    v_exp_f32 v125, v125
    v_exp_f32 v110, v110
    v_exp_f32 v126, v126
    v_exp_f32 v111, v111
    v_exp_f32 v127, v127
    v_exp_f32 v112, v112
    v_exp_f32 v128, v128
    v_exp_f32 v113, v113
    v_exp_f32 v129, v129
    v_exp_f32 v114, v114
    v_exp_f32 v130, v130
    v_exp_f32 v115, v115
    v_exp_f32 v131, v131
    v_exp_f32 v116, v116
    v_exp_f32 v132, v132
    v_exp_f32 v117, v117
    v_exp_f32 v133, v133
    v_exp_f32 v118, v118
    v_exp_f32 v134, v134
    v_exp_f32 v119, v119
    v_exp_f32 v135, v135
    v_cndmask_b32 v116, v116, 0, s[72:73]
    v_cndmask_b32 v132, v132, 0, s[72:73]
    v_cndmask_b32 v117, v117, 0, s[72:73]
    v_cndmask_b32 v133, v133, 0, s[72:73]
    v_cndmask_b32 v118, v118, 0, s[72:73]
    v_cndmask_b32 v134, v134, 0, s[72:73]
    v_cndmask_b32 v119, v119, 0, s[72:73]
    v_cndmask_b32 v135, v135, 0, s[72:73]
    v_add_f32 v98, v104, v105
    v_add_f32 v99, v120, v121
    v_add_f32 v100, v106, v107
    v_add_f32 v101, v122, v123
    v_add_f32 v98, v98, v108
    v_add_f32 v99, v99, v124
    v_add_f32 v100, v100, v109
    v_add_f32 v101, v101, v125
    v_add_f32 v98, v98, v110
    v_add_f32 v99, v99, v126
    v_add_f32 v100, v100, v111
    v_add_f32 v101, v101, v127
    v_add_f32 v98, v98, v112
    v_add_f32 v99, v99, v128
    v_add_f32 v100, v100, v113
    v_add_f32 v101, v101, v129
    v_add_f32 v98, v98, v114
    v_add_f32 v99, v99, v130
    v_add_f32 v100, v100, v115
    v_add_f32 v101, v101, v131
    v_add_f32 v98, v98, v116
    v_add_f32 v99, v99, v132
    v_add_f32 v100, v100, v117
    v_add_f32 v101, v101, v133
    v_add_f32 v98, v98, v118
    v_add_f32 v99, v99, v134
    v_add_f32 v100, v100, v119
    v_add_f32 v101, v101, v135
    v_add_f32 v98, v98, v100
    v_add_f32 v99, v99, v101
    v_mov_b32 v100, v98
    v_mov_b32 v101, v98
    v_mov_b32 v102, v99
    v_mov_b32 v103, v99
    v_permlane32_swap_b32 v100, v101
    s_nop 0
    v_permlane32_swap_b32 v102, v103
    v_add_f32 v98, v100, v101
    v_add_f32 v99, v102, v103
    v_log_f32 v98, v98
    v_log_f32 v99, v99
    v_fma_f32 v98, -v98, s81, -v96
    v_fma_f32 v99, -v99, s81, v97
    v_cvt_pk_bf16_f32 v100, v98, v98
    v_lshlrev_b32 v100, 16, v100
    v_sub_f32 v100, v98, v100
    v_cvt_pk_bf16_f32 v100, v98, v100
    v_cvt_pk_bf16_f32 v101, v99, v99
    v_lshlrev_b32 v101, 16, v101
    v_sub_f32 v101, v99, v101
    v_cvt_pk_bf16_f32 v101, v99, v101
    v_cndmask_b32 v54, v54, v100, s[72:73]
    v_cndmask_b32 v55, v55, v101, s[72:73]
    v_mfma_f32_32x32x16_bf16 v[16:31], v[48:51], v[64:67], 0
    v_mfma_f32_32x32x16_bf16 v[32:47], v[48:51], v[80:83], 0
    v_mfma_f32_32x32x16_bf16 v[16:31], v[52:55], v[76:79], v[16:31]
    v_mfma_f32_32x32x16_bf16 v[32:47], v[52:55], v[84:87], v[32:47]
    s_nop 10
    v_mul_f32 v16, s80, v16
    v_mul_f32 v17, s80, v17
    v_mul_f32 v18, s80, v18
    v_mul_f32 v19, s80, v19
    v_mul_f32 v20, s80, v20
    v_mul_f32 v21, s80, v21
    v_mul_f32 v22, s80, v22
    v_mul_f32 v23, s80, v23
    v_mul_f32 v24, s80, v24
    v_mul_f32 v25, s80, v25
    v_mul_f32 v26, s80, v26
    v_mul_f32 v27, s80, v27
    v_mul_f32 v28, s80, v28
    v_mul_f32 v29, s80, v29
    v_mul_f32 v30, s80, v30
    v_mul_f32 v31, s80, v31
    v_exp_f32 v16, v16
    v_mul_f32 v32, s80, v32
    v_exp_f32 v17, v17
    v_mul_f32 v33, s80, v33
    v_exp_f32 v18, v18
    v_mul_f32 v34, s80, v34
    v_exp_f32 v19, v19
    v_mul_f32 v35, s80, v35
    v_exp_f32 v20, v20
    v_mul_f32 v36, s80, v36
    v_exp_f32 v21, v21
    v_mul_f32 v37, s80, v37
    v_exp_f32 v22, v22
    v_mul_f32 v38, s80, v38
    v_exp_f32 v23, v23
    v_mul_f32 v39, s80, v39
    v_exp_f32 v24, v24
    v_mul_f32 v40, s80, v40
    v_exp_f32 v25, v25
    v_mul_f32 v41, s80, v41
    v_exp_f32 v26, v26
    v_mul_f32 v42, s80, v42
    v_exp_f32 v27, v27
    v_mul_f32 v43, s80, v43
    v_exp_f32 v28, v28
    v_mul_f32 v44, s80, v44
    v_exp_f32 v29, v29
    v_mul_f32 v45, s80, v45
    v_exp_f32 v30, v30
    v_mul_f32 v46, s80, v46
    v_exp_f32 v31, v31
    v_mul_f32 v47, s80, v47
    v_exp_f32 v32, v32
    v_exp_f32 v33, v33
    v_exp_f32 v34, v34
    v_exp_f32 v35, v35
    v_exp_f32 v36, v36
    v_exp_f32 v37, v37
    v_exp_f32 v38, v38
    v_exp_f32 v39, v39
    v_exp_f32 v40, v40
    v_exp_f32 v41, v41
    v_exp_f32 v42, v42
    v_exp_f32 v43, v43
    v_exp_f32 v44, v44
    v_exp_f32 v45, v45
    v_exp_f32 v46, v46
    v_exp_f32 v47, v47
    v_cvt_pk_bf16_f32 v96, v16, v17
    v_cvt_pk_bf16_f32 v97, v18, v19
    v_cvt_pk_bf16_f32 v98, v20, v21
    v_cvt_pk_bf16_f32 v99, v22, v23
    v_cvt_pk_bf16_f32 v100, v24, v25
    v_cvt_pk_bf16_f32 v101, v26, v27
    v_cvt_pk_bf16_f32 v102, v28, v29
    v_cvt_pk_bf16_f32 v103, v30, v31
    v_cvt_pk_bf16_f32 v104, v32, v33
    v_cvt_pk_bf16_f32 v105, v34, v35
    v_cvt_pk_bf16_f32 v106, v36, v37
    v_cvt_pk_bf16_f32 v107, v38, v39
    v_cvt_pk_bf16_f32 v108, v40, v41
    v_cvt_pk_bf16_f32 v109, v42, v43
    v_cvt_pk_bf16_f32 v110, v44, v45
    v_cvt_pk_bf16_f32 v111, v46, v47
    v_mfma_f32_32x32x16_bf16 v[16:31], v[96:99], v[56:59], 0
    v_mfma_f32_32x32x16_bf16 v[32:47], v[104:107], v[56:59], 0
    v_mfma_f32_32x32x16_bf16 v[16:31], v[100:103], v[60:63], v[16:31]
    v_mfma_f32_32x32x16_bf16 v[32:47], v[108:111], v[60:63], v[32:47]
    s_barrier
    s_lshl_b32 s57, s14, 13
    s_add_u32 s57, s57, 0
    v_lshlrev_b32 v14, 4, v1
    v_add_u32 v15, s57, v14
    s_nop 5
    ds_write_b128 v15, v[16:19] offset:0
    ds_write_b128 v15, v[20:23] offset:1024
    ds_write_b128 v15, v[24:27] offset:2048
    ds_write_b128 v15, v[28:31] offset:3072
    ds_write_b128 v15, v[32:35] offset:4096
    ds_write_b128 v15, v[36:39] offset:5120
    ds_write_b128 v15, v[40:43] offset:6144
    ds_write_b128 v15, v[44:47] offset:7168
    s_waitcnt lgkmcnt(0)
    s_barrier
    s_lshl_b32 s57, s14, 11
    s_add_u32 s57, s57, 0
    v_add_u32 v15, s57, v14
    ds_read_b128 v[96:99], v15 offset:0
    ds_read_b128 v[100:103], v15 offset:1024
    ds_read_b128 v[104:107], v15 offset:8192
    ds_read_b128 v[108:111], v15 offset:9216
    ds_read_b128 v[112:115], v15 offset:16384
    ds_read_b128 v[116:119], v15 offset:17408
    ds_read_b128 v[120:123], v15 offset:24576
    ds_read_b128 v[124:127], v15 offset:25600
    s_lshl_b32 s57, s79, 4
    s_add_u32 s57, s57, s78
    s_lshl_b32 s57, s57, 2
    s_add_u32 s57, s57, s14
    s_lshl_b32 s57, s57, 10
    s_add_u32 s57, s57, 8388608
    v_add_u32 v15, s57, v14
    s_mov_b32 s57, 0
    s_branch L_nonc_10
L_non_8:
    global_load_dwordx2 v[92:93], v94, s[46:47] sc0 sc1
    s_waitcnt vmcnt(0)
L_nonc_10:
    s_waitcnt vmcnt(0)
    v_readfirstlane_b32 s12, v92
    v_readfirstlane_b32 s13, v93
    s_nop 0
    s_cmp_lg_u32 s12, 0
    s_cbranch_scc1 L_nond_9
    s_add_u32 s57, s57, 1
    s_cmp_ge_u32 s57, 200000
    s_cbranch_scc1 L_nond_9
    s_sleep 1
    s_branch L_non_8
L_nond_9:
    s_waitcnt lgkmcnt(0)
    v_add_f32 v96, v96, v104
    v_add_f32 v112, v112, v120
    v_add_f32 v97, v97, v105
    v_add_f32 v113, v113, v121
    v_add_f32 v98, v98, v106
    v_add_f32 v114, v114, v122
    v_add_f32 v99, v99, v107
    v_add_f32 v115, v115, v123
    v_add_f32 v100, v100, v108
    v_add_f32 v116, v116, v124
    v_add_f32 v101, v101, v109
    v_add_f32 v117, v117, v125
    v_add_f32 v102, v102, v110
    v_add_f32 v118, v118, v126
    v_add_f32 v103, v103, v111
    v_add_f32 v119, v119, v127
    v_add_f32 v96, v96, v112
    v_add_f32 v97, v97, v113
    v_add_f32 v98, v98, v114
    v_add_f32 v99, v99, v115
    v_add_f32 v100, v100, v116
    v_add_f32 v101, v101, v117
    v_add_f32 v102, v102, v118
    v_add_f32 v103, v103, v119
    v_cvt_pk_bf16_f32 v104, v96, v97
    v_cvt_pk_bf16_f32 v105, v98, v99
    v_cvt_pk_bf16_f32 v106, v100, v101
    v_cvt_pk_bf16_f32 v107, v102, v103
    buffer_store_dwordx4 v[104:107], v15, s[4:7], 0 offen sc0 sc1
    s_mul_i32 s57, s62, 172032
    s_add_u32 s57, s57, s55
    s_add_u32 m0, s56, 53248
    s_add_u32 s62, s62, 1
    s_cmp_eq_u32 s62, 7
    s_cselect_b32 s62, 0, s62
    buffer_load_dwordx4 v8, s[64:67], s57 offen lds
    s_lshl_b32 s57, s79, 2
    s_add_u32 s57, s57, s14
    s_lshl_b32 s57, s57, 4
    s_add_u32 s58, s57, s78
    s_lshl_b32 s58, s58, 3
    s_add_u32 s58, s58, 11550720
    v_mov_b32 v86, s58
    s_lshl_b32 s88, s57, 3
    v_lshlrev_b32 v14, 5, v143
    ds_write_b16 v14, v12 offset:57400
    v_add_u32 v15, 73784, v14
    v_add_u32 v9, 45112, v14
    s_mov_b32 exec_hi, 0
    ds_write_b16 v15, v13
    s_mov_b64 exec, -1
    s_waitcnt lgkmcnt(0)
    s_barrier
    v_add_u32 v10, 57344, v11
    ds_read_b64_tr_b16 v[88:89], v10 offset:0
    ds_read_b64_tr_b16 v[90:91], v10 offset:256
    ds_read_b64_tr_b16 v[92:93], v10 offset:512
    ds_read_b64_tr_b16 v[94:95], v10 offset:768
    ds_read_b64_tr_b16 v[96:97], v10 offset:1024
    ds_read_b64_tr_b16 v[98:99], v10 offset:1280
    ds_read_b64_tr_b16 v[100:101], v10 offset:1536
    ds_read_b64_tr_b16 v[102:103], v10 offset:1792
    ds_read_b64_tr_b16 v[104:105], v10 offset:4096
    ds_read_b64_tr_b16 v[106:107], v10 offset:4352
    ds_read_b64_tr_b16 v[108:109], v10 offset:4608
    ds_read_b64_tr_b16 v[110:111], v10 offset:4864
    ds_read_b64_tr_b16 v[112:113], v10 offset:5120
    ds_read_b64_tr_b16 v[114:115], v10 offset:5376
    ds_read_b64_tr_b16 v[116:117], v10 offset:5632
    ds_read_b64_tr_b16 v[118:119], v10 offset:5888
    ds_read_b64_tr_b16 v[120:121], v10 offset:8192
    ds_read_b64_tr_b16 v[122:123], v10 offset:8448
    ds_read_b64_tr_b16 v[124:125], v10 offset:8704
    ds_read_b64_tr_b16 v[126:127], v10 offset:8960
    ds_read_b64_tr_b16 v[128:129], v10 offset:9216
    ds_read_b64_tr_b16 v[130:131], v10 offset:9472
    ds_read_b64_tr_b16 v[132:133], v10 offset:9728
    ds_read_b64_tr_b16 v[134:135], v10 offset:9984
    ds_read_b64_tr_b16 v[136:137], v10 offset:12288
    ds_read_b64_tr_b16 v[138:139], v10 offset:12544
    ds_read_b64_tr_b16 v[140:141], v10 offset:12800
    ds_read_b64_tr_b16 v[142:143], v10 offset:13056
    s_waitcnt lgkmcnt(14)
    v_mfma_f32_32x32x16_bf16 v[16:31], v[88:91], v[144:147], 0
    v_mfma_f32_32x32x16_bf16 v[16:31], v[92:95], v[148:151], v[16:31]
    v_mfma_f32_32x32x16_bf16 v[16:31], v[96:99], v[152:155], v[16:31]
    v_mfma_f32_32x32x16_bf16 v[16:31], v[100:103], v[156:159], v[16:31]
    v_mfma_f32_32x32x16_bf16 v[16:31], v[104:107], v[160:163], v[16:31]
    v_mfma_f32_32x32x16_bf16 v[16:31], v[108:111], v[164:167], v[16:31]
    v_mfma_f32_32x32x16_bf16 v[16:31], v[112:115], v[168:171], v[16:31]
    ds_read_b64_tr_b16 v[88:89], v10 offset:13312
    ds_read_b64_tr_b16 v[90:91], v10 offset:13568
    ds_read_b64_tr_b16 v[92:93], v10 offset:13824
    ds_read_b64_tr_b16 v[94:95], v10 offset:14080
    ds_read_b64_tr_b16 v[96:97], v10 offset:16384
    ds_read_b64_tr_b16 v[98:99], v10 offset:16640
    ds_read_b64_tr_b16 v[100:101], v10 offset:16896
    ds_read_b64_tr_b16 v[102:103], v10 offset:17152
    ds_read_b64_tr_b16 v[104:105], v10 offset:17408
    ds_read_b64_tr_b16 v[106:107], v10 offset:17664
    ds_read_b64_tr_b16 v[108:109], v10 offset:17920
    ds_read_b64_tr_b16 v[110:111], v10 offset:18176
    ds_read_b64_tr_b16 v[112:113], v10 offset:20480
    ds_read_b64_tr_b16 v[114:115], v10 offset:20736
    s_waitcnt lgkmcnt(14)
    v_mfma_f32_32x32x16_bf16 v[16:31], v[116:119], v[172:175], v[16:31]
    v_mfma_f32_32x32x16_bf16 v[16:31], v[120:123], v[176:179], v[16:31]
    v_mfma_f32_32x32x16_bf16 v[16:31], v[124:127], v[180:183], v[16:31]
    v_mfma_f32_32x32x16_bf16 v[16:31], v[128:131], v[184:187], v[16:31]
    v_mfma_f32_32x32x16_bf16 v[16:31], v[132:135], v[188:191], v[16:31]
    v_mfma_f32_32x32x16_bf16 v[16:31], v[136:139], v[192:195], v[16:31]
    v_mfma_f32_32x32x16_bf16 v[16:31], v[140:143], v[196:199], v[16:31]
    s_waitcnt vmcnt(0)
    v_mov_b32 v84, s12
    v_mov_b32 v85, s13
    s_mov_b64 exec, 1
    buffer_store_dwordx2 v[84:85], v86, s[4:7], 0 offen sc0 sc1
    s_mov_b64 exec, -1
    s_mov_b32 exec_lo, 0
    s_mov_b32 exec_hi, 0xffff
    ds_write_b16 v9, v13
    s_mov_b64 exec, -1
    s_waitcnt lgkmcnt(0)
    s_barrier
    ds_read_b64_tr_b16 v[116:117], v10 offset:20992
    ds_read_b64_tr_b16 v[118:119], v10 offset:21248
    ds_read_b64_tr_b16 v[120:121], v10 offset:21504
    ds_read_b64_tr_b16 v[122:123], v10 offset:21760
    ds_read_b64_tr_b16 v[124:125], v10 offset:22016
    ds_read_b64_tr_b16 v[126:127], v10 offset:22272
    ds_read_b64_tr_b16 v[128:129], v11 offset:53248
    ds_read_b64_tr_b16 v[130:131], v11 offset:53504
    ds_read_b64_tr_b16 v[132:133], v11 offset:53760
    ds_read_b64_tr_b16 v[134:135], v11 offset:54016
    ds_read_b64_tr_b16 v[136:137], v11 offset:54272
    ds_read_b64_tr_b16 v[138:139], v11 offset:54528
    ds_read_b64_tr_b16 v[140:141], v11 offset:54784
    ds_read_b64_tr_b16 v[142:143], v11 offset:55040
    s_waitcnt lgkmcnt(14)
    v_mfma_f32_32x32x16_bf16 v[16:31], v[88:91], v[200:203], v[16:31]
    v_mfma_f32_32x32x16_bf16 v[16:31], v[92:95], v[204:207], v[16:31]
    v_mfma_f32_32x32x16_bf16 v[16:31], v[96:99], v[208:211], v[16:31]
    v_mfma_f32_32x32x16_bf16 v[16:31], v[100:103], v[212:215], v[16:31]
    v_mfma_f32_32x32x16_bf16 v[16:31], v[104:107], v[216:219], v[16:31]
    v_mfma_f32_32x32x16_bf16 v[16:31], v[108:111], v[220:223], v[16:31]
    v_mfma_f32_32x32x16_bf16 v[16:31], v[112:115], v[224:227], v[16:31]
    s_waitcnt lgkmcnt(0)
    v_mfma_f32_32x32x16_bf16 v[16:31], v[116:119], v[228:231], v[16:31]
    v_mfma_f32_32x32x16_bf16 v[16:31], v[120:123], v[232:235], v[16:31]
    v_mfma_f32_32x32x16_bf16 v[16:31], v[124:127], v[236:239], v[16:31]
    v_mfma_f32_32x32x16_bf16 v[16:31], v[128:131], v[240:243], v[16:31]
    v_mfma_f32_32x32x16_bf16 v[16:31], v[132:135], v[244:247], v[16:31]
    v_mfma_f32_32x32x16_bf16 v[16:31], v[136:139], v[248:251], v[16:31]
    v_mfma_f32_32x32x16_bf16 v[16:31], v[140:143], v[252:255], v[16:31]
    s_barrier
    s_nop 10
    v_mov_b32 v14, v28
    v_cvt_pk_bf16_f32 v48, v16, v17
    v_cvt_pk_bf16_f32 v49, v18, v19
    v_cvt_pk_bf16_f32 v50, v20, v21
    v_cvt_pk_bf16_f32 v51, v22, v23
    v_cvt_pk_bf16_f32 v52, v24, v25
    v_cvt_pk_bf16_f32 v53, v26, v27
    v_cvt_pk_bf16_f32 v54, v28, v29
    v_cvt_pk_bf16_f32 v55, v30, v31
    v_mfma_f32_32x32x16_bf16 v[16:31], v[64:67], v[48:51], 0
    s_nop 0
    v_mfma_f32_32x32x16_bf16 v[16:31], v[72:75], v[52:55], v[16:31]
    v_mul_f32 v14, s80, v14
    v_exp_f32 v14, -v14
    s_nop 0
    v_add_f32 v14, 1.0, v14
    v_rcp_f32 v14, v14
    s_cmp_lg_u32 s79, 0
    s_cbranch_scc1 L_ng_11
    v_lshlrev_b32 v15, 2, v4
    v_add_u32 v15, 10485760, v15
    s_mov_b64 exec, s[72:73]
    buffer_store_dword v14, v15, s[4:7], 0 offen sc0 sc1
    s_mov_b64 exec, -1
L_ng_11:
    s_nop 4
    v_cndmask_b32 v28, v28, v27, s[72:73]
    v_cndmask_b32 v29, v29, v27, s[72:73]
    v_cndmask_b32 v30, v30, v27, s[72:73]
    v_cndmask_b32 v31, v31, v27, s[72:73]
    v_max3_f32 v96, v16, v17, v18
    v_min3_f32 v97, v16, v17, v18
    v_max3_f32 v96, v96, v19, v20
    v_min3_f32 v97, v97, v19, v20
    v_max3_f32 v96, v96, v21, v22
    v_min3_f32 v97, v97, v21, v22
    v_max3_f32 v96, v96, v23, v24
    v_min3_f32 v97, v97, v23, v24
    v_max3_f32 v96, v96, v25, v26
    v_min3_f32 v97, v97, v25, v26
    v_max3_f32 v96, v96, v27, v28
    v_min3_f32 v97, v97, v27, v28
    v_max3_f32 v96, v96, v29, v30
    v_min3_f32 v97, v97, v29, v30
    v_max_f32 v96, v96, v31
    v_min_f32 v97, v97, v31
    v_mov_b32 v100, v96
    v_mov_b32 v101, v96
    v_mov_b32 v102, v97
    v_mov_b32 v103, v97
    v_permlane32_swap_b32 v100, v101
    s_nop 0
    v_permlane32_swap_b32 v102, v103
    v_max_f32 v96, v100, v101
    v_min_f32 v97, v102, v103
    v_mul_f32 v102, s80, v96
    v_mul_f32 v103, s80, v97
    v_fma_f32 v104, v16, s80, -v102
    v_fma_f32 v120, -v16, s80, v103
    v_fma_f32 v105, v17, s80, -v102
    v_fma_f32 v121, -v17, s80, v103
    v_fma_f32 v106, v18, s80, -v102
    v_fma_f32 v122, -v18, s80, v103
    v_fma_f32 v107, v19, s80, -v102
    v_fma_f32 v123, -v19, s80, v103
    v_fma_f32 v108, v20, s80, -v102
    v_fma_f32 v124, -v20, s80, v103
    v_fma_f32 v109, v21, s80, -v102
    v_fma_f32 v125, -v21, s80, v103
    v_fma_f32 v110, v22, s80, -v102
    v_fma_f32 v126, -v22, s80, v103
    v_fma_f32 v111, v23, s80, -v102
    v_fma_f32 v127, -v23, s80, v103
    v_fma_f32 v112, v24, s80, -v102
    v_fma_f32 v128, -v24, s80, v103
    v_fma_f32 v113, v25, s80, -v102
    v_fma_f32 v129, -v25, s80, v103
    v_fma_f32 v114, v26, s80, -v102
    v_fma_f32 v130, -v26, s80, v103
    v_fma_f32 v115, v27, s80, -v102
    v_fma_f32 v131, -v27, s80, v103
    v_fma_f32 v116, v28, s80, -v102
    v_fma_f32 v132, -v28, s80, v103
    v_fma_f32 v117, v29, s80, -v102
    v_fma_f32 v133, -v29, s80, v103
    v_fma_f32 v118, v30, s80, -v102
    v_fma_f32 v134, -v30, s80, v103
    v_fma_f32 v119, v31, s80, -v102
    v_fma_f32 v135, -v31, s80, v103
    v_exp_f32 v104, v104
    v_exp_f32 v120, v120
    v_exp_f32 v105, v105
    v_exp_f32 v121, v121
    v_exp_f32 v106, v106
    v_exp_f32 v122, v122
    v_exp_f32 v107, v107
    v_exp_f32 v123, v123
    v_exp_f32 v108, v108
    v_exp_f32 v124, v124
    v_exp_f32 v109, v109
    v_exp_f32 v125, v125
    v_exp_f32 v110, v110
    v_exp_f32 v126, v126
    v_exp_f32 v111, v111
    v_exp_f32 v127, v127
    v_exp_f32 v112, v112
    v_exp_f32 v128, v128
    v_exp_f32 v113, v113
    v_exp_f32 v129, v129
    v_exp_f32 v114, v114
    v_exp_f32 v130, v130
    v_exp_f32 v115, v115
    v_exp_f32 v131, v131
    v_exp_f32 v116, v116
    v_exp_f32 v132, v132
    v_exp_f32 v117, v117
    v_exp_f32 v133, v133
    v_exp_f32 v118, v118
    v_exp_f32 v134, v134
    v_exp_f32 v119, v119
    v_exp_f32 v135, v135
    v_cndmask_b32 v116, v116, 0, s[72:73]
    v_cndmask_b32 v132, v132, 0, s[72:73]
    v_cndmask_b32 v117, v117, 0, s[72:73]
    v_cndmask_b32 v133, v133, 0, s[72:73]
    v_cndmask_b32 v118, v118, 0, s[72:73]
    v_cndmask_b32 v134, v134, 0, s[72:73]
    v_cndmask_b32 v119, v119, 0, s[72:73]
    v_cndmask_b32 v135, v135, 0, s[72:73]
    v_add_f32 v98, v104, v105
    v_add_f32 v99, v120, v121
    v_add_f32 v100, v106, v107
    v_add_f32 v101, v122, v123
    v_add_f32 v98, v98, v108
    v_add_f32 v99, v99, v124
    v_add_f32 v100, v100, v109
    v_add_f32 v101, v101, v125
    v_add_f32 v98, v98, v110
    v_add_f32 v99, v99, v126
    v_add_f32 v100, v100, v111
    v_add_f32 v101, v101, v127
    v_add_f32 v98, v98, v112
    v_add_f32 v99, v99, v128
    v_add_f32 v100, v100, v113
    v_add_f32 v101, v101, v129
    v_add_f32 v98, v98, v114
    v_add_f32 v99, v99, v130
    v_add_f32 v100, v100, v115
    v_add_f32 v101, v101, v131
    v_add_f32 v98, v98, v116
    v_add_f32 v99, v99, v132
    v_add_f32 v100, v100, v117
    v_add_f32 v101, v101, v133
    v_add_f32 v98, v98, v118
    v_add_f32 v99, v99, v134
    v_add_f32 v100, v100, v119
    v_add_f32 v101, v101, v135
    v_add_f32 v98, v98, v100
    v_add_f32 v99, v99, v101
    v_mov_b32 v100, v98
    v_mov_b32 v101, v98
    v_mov_b32 v102, v99
    v_mov_b32 v103, v99
    v_permlane32_swap_b32 v100, v101
    s_nop 0
    v_permlane32_swap_b32 v102, v103
    v_add_f32 v98, v100, v101
    v_add_f32 v99, v102, v103
    v_and_b32 v86, 15, v1
    v_lshlrev_b32 v86, 3, v86
    s_add_u32 s57, s88, 11550720
    v_add_u32 v86, s57, v86
    buffer_load_dwordx2 v[84:85], v86, s[4:7], 0 offen sc0 sc1
    v_rcp_f32 v98, v98
    v_rcp_f32 v99, v99
    v_mul_f32 v104, v104, v98
    v_mul_f32 v120, v120, v99
    v_mul_f32 v105, v105, v98
    v_mul_f32 v121, v121, v99
    v_mul_f32 v106, v106, v98
    v_mul_f32 v122, v122, v99
    v_mul_f32 v107, v107, v98
    v_mul_f32 v123, v123, v99
    v_mul_f32 v108, v108, v98
    v_mul_f32 v124, v124, v99
    v_mul_f32 v109, v109, v98
    v_mul_f32 v125, v125, v99
    v_mul_f32 v110, v110, v98
    v_mul_f32 v126, v126, v99
    v_mul_f32 v111, v111, v98
    v_mul_f32 v127, v127, v99
    v_mul_f32 v112, v112, v98
    v_mul_f32 v128, v128, v99
    v_mul_f32 v113, v113, v98
    v_mul_f32 v129, v129, v99
    v_mul_f32 v114, v114, v98
    v_mul_f32 v130, v130, v99
    v_mul_f32 v115, v115, v98
    v_mul_f32 v131, v131, v99
    v_mul_f32 v116, v116, v98
    v_mul_f32 v132, v132, v99
    v_mul_f32 v117, v117, v98
    v_mul_f32 v133, v133, v99
    v_mul_f32 v118, v118, v98
    v_mul_f32 v134, v134, v99
    v_mul_f32 v119, v119, v98
    v_mul_f32 v135, v135, v99
    v_cvt_pk_bf16_f32 v48, v104, v105
    v_cvt_pk_bf16_f32 v56, v120, v121
    v_cvt_pk_bf16_f32 v49, v106, v107
    v_cvt_pk_bf16_f32 v57, v122, v123
    v_cvt_pk_bf16_f32 v50, v108, v109
    v_cvt_pk_bf16_f32 v58, v124, v125
    v_cvt_pk_bf16_f32 v51, v110, v111
    v_cvt_pk_bf16_f32 v59, v126, v127
    v_cvt_pk_bf16_f32 v52, v112, v113
    v_cvt_pk_bf16_f32 v60, v128, v129
    v_cvt_pk_bf16_f32 v53, v114, v115
    v_cvt_pk_bf16_f32 v61, v130, v131
    v_cvt_pk_bf16_f32 v54, v116, v117
    v_cvt_pk_bf16_f32 v62, v132, v133
    v_cvt_pk_bf16_f32 v55, v118, v119
    v_cvt_pk_bf16_f32 v63, v134, v135
    v_lshrrev_b32 v8, 3, v2
    v_bfe_u32 v9, v2, 2, 1
    v_and_b32 v10, 3, v2
    v_lshrrev_b32 v12, 1, v10
    v_lshl_add_u32 v12, v8, 1, v12
    v_and_b32 v13, 1, v10
    v_mov_b32 v14, 0x3f80
    v_mov_b32 v15, 0x3f800000
    v_cmp_eq_u32 vcc, 1, v13
    s_nop 1
    v_cndmask_b32 v13, v14, v15, vcc
    v_cmp_eq_u32 vcc, v9, v3
    s_nop 1
    v_cndmask_b32 v13, 0, v13, vcc
    v_cmp_eq_u32 vcc, 0, v12
    s_nop 1
    v_cndmask_b32 v64, 0, v13, vcc
    v_cmp_eq_u32 vcc, 1, v12
    s_nop 1
    v_cndmask_b32 v65, 0, v13, vcc
    v_cmp_eq_u32 vcc, 2, v12
    s_nop 1
    v_cndmask_b32 v66, 0, v13, vcc
    v_cmp_eq_u32 vcc, 3, v12
    s_nop 1
    v_cndmask_b32 v67, 0, v13, vcc
    s_waitcnt vmcnt(0)
    v_cmp_eq_u64 vcc, s[12:13], v[84:85]
    s_nop 1
    s_cmp_eq_u64 vcc, exec
    s_cbranch_scc1 L_fkok_12
    s_mov_b32 s57, 0
L_poll_13:
    buffer_load_dwordx2 v[84:85], v86, s[4:7], 0 offen sc0 sc1
    s_waitcnt vmcnt(0)
    v_cmp_eq_u64 vcc, s[12:13], v[84:85]
    s_nop 1
    s_cmp_eq_u64 vcc, exec
    s_cbranch_scc1 L_polld_14
    s_add_u32 s57, s57, 1
    s_cmp_ge_u32 s57, 200000
    s_cbranch_scc1 L_polld_14
    s_sleep 1
    s_branch L_poll_13
L_polld_14:
L_fkok_12:
    s_lshl_b32 s57, s79, 6
    s_add_u32 s57, s57, s14
    s_lshl_b32 s57, s57, 10
    s_add_u32 s57, s57, 8388608
    v_lshlrev_b32 v9, 4, v1
    v_add_u32 v8, s57, v9
    s_mov_b32 s57, 0
    buffer_load_dwordx4 v[144:147], v8, s[4:7], s57 offen sc0 sc1
    s_mov_b32 s57, 4096
    buffer_load_dwordx4 v[148:151], v8, s[4:7], s57 offen sc0 sc1
    s_mov_b32 s57, 8192
    buffer_load_dwordx4 v[152:155], v8, s[4:7], s57 offen sc0 sc1
    s_mov_b32 s57, 12288
    buffer_load_dwordx4 v[156:159], v8, s[4:7], s57 offen sc0 sc1
    s_mov_b32 s57, 16384
    buffer_load_dwordx4 v[160:163], v8, s[4:7], s57 offen sc0 sc1
    s_mov_b32 s57, 20480
    buffer_load_dwordx4 v[164:167], v8, s[4:7], s57 offen sc0 sc1
    s_mov_b32 s57, 24576
    buffer_load_dwordx4 v[168:171], v8, s[4:7], s57 offen sc0 sc1
    s_mov_b32 s57, 28672
    buffer_load_dwordx4 v[172:175], v8, s[4:7], s57 offen sc0 sc1
    s_mov_b32 s57, 32768
    buffer_load_dwordx4 v[176:179], v8, s[4:7], s57 offen sc0 sc1
    s_mov_b32 s57, 36864
    buffer_load_dwordx4 v[180:183], v8, s[4:7], s57 offen sc0 sc1
    s_mov_b32 s57, 40960
    buffer_load_dwordx4 v[184:187], v8, s[4:7], s57 offen sc0 sc1
    s_mov_b32 s57, 45056
    buffer_load_dwordx4 v[188:191], v8, s[4:7], s57 offen sc0 sc1
    s_mov_b32 s57, 49152
    buffer_load_dwordx4 v[192:195], v8, s[4:7], s57 offen sc0 sc1
    s_mov_b32 s57, 53248
    buffer_load_dwordx4 v[196:199], v8, s[4:7], s57 offen sc0 sc1
    s_mov_b32 s57, 57344
    buffer_load_dwordx4 v[200:203], v8, s[4:7], s57 offen sc0 sc1
    s_mov_b32 s57, 61440
    buffer_load_dwordx4 v[204:207], v8, s[4:7], s57 offen sc0 sc1
    s_waitcnt vmcnt(15)
    v_mfma_f32_32x32x16_bf16 v[16:31], v[64:67], v[144:147], 0
    s_waitcnt vmcnt(14)
    v_mfma_f32_32x32x16_bf16 v[16:31], v[64:67], v[148:151], v[16:31]
    s_waitcnt vmcnt(13)
    v_mfma_f32_32x32x16_bf16 v[16:31], v[64:67], v[152:155], v[16:31]
    s_waitcnt vmcnt(12)
    v_mfma_f32_32x32x16_bf16 v[16:31], v[64:67], v[156:159], v[16:31]
    s_waitcnt vmcnt(11)
    v_mfma_f32_32x32x16_bf16 v[16:31], v[64:67], v[160:163], v[16:31]
    s_waitcnt vmcnt(10)
    v_mfma_f32_32x32x16_bf16 v[16:31], v[64:67], v[164:167], v[16:31]
    s_waitcnt vmcnt(9)
    v_mfma_f32_32x32x16_bf16 v[16:31], v[64:67], v[168:171], v[16:31]
    s_waitcnt vmcnt(8)
    v_mfma_f32_32x32x16_bf16 v[16:31], v[64:67], v[172:175], v[16:31]
    s_waitcnt vmcnt(7)
    v_mfma_f32_32x32x16_bf16 v[16:31], v[64:67], v[176:179], v[16:31]
    s_waitcnt vmcnt(6)
    v_mfma_f32_32x32x16_bf16 v[16:31], v[64:67], v[180:183], v[16:31]
    s_waitcnt vmcnt(5)
    v_mfma_f32_32x32x16_bf16 v[16:31], v[64:67], v[184:187], v[16:31]
    s_waitcnt vmcnt(4)
    v_mfma_f32_32x32x16_bf16 v[16:31], v[64:67], v[188:191], v[16:31]
    s_waitcnt vmcnt(3)
    v_mfma_f32_32x32x16_bf16 v[16:31], v[64:67], v[192:195], v[16:31]
    s_waitcnt vmcnt(2)
    v_mfma_f32_32x32x16_bf16 v[16:31], v[64:67], v[196:199], v[16:31]
    s_waitcnt vmcnt(1)
    v_mfma_f32_32x32x16_bf16 v[16:31], v[64:67], v[200:203], v[16:31]
    s_waitcnt vmcnt(0)
    v_mfma_f32_32x32x16_bf16 v[16:31], v[64:67], v[204:207], v[16:31]
    s_nop 11
    v_cvt_pk_bf16_f32 v96, v16, v17
    v_cvt_pk_bf16_f32 v97, v18, v19
    v_cvt_pk_bf16_f32 v98, v20, v21
    v_cvt_pk_bf16_f32 v99, v22, v23
    s_lshl_b32 s57, s14, 10
    s_add_u32 s57, s57, 61440
    v_add_u32 v8, s57, v9
    ds_write_b128 v8, v[96:99]
    s_waitcnt lgkmcnt(0)
    s_barrier
    v_add_u32 v8, 61440, v9
    ds_read_b128 v[100:103], v8 offset:0
    ds_read_b128 v[104:107], v8 offset:1024
    ds_read_b128 v[108:111], v8 offset:2048
    ds_read_b128 v[112:115], v8 offset:3072
    s_waitcnt lgkmcnt(3)
    v_mfma_f32_32x32x16_bf16 v[16:31], v[100:103], v[48:51], 0
    s_waitcnt lgkmcnt(2)
    v_mfma_f32_32x32x16_bf16 v[16:31], v[104:107], v[52:55], v[16:31]
    s_waitcnt lgkmcnt(1)
    v_mfma_f32_32x32x16_bf16 v[16:31], v[108:111], v[56:59], v[16:31]
    s_waitcnt lgkmcnt(0)
    v_mfma_f32_32x32x16_bf16 v[16:31], v[112:115], v[60:63], v[16:31]
    s_nop 11
    v_mov_b32 v8, v28
    v_mov_b32 v9, v28
    s_nop 1
    v_permlane32_swap_b32 v8, v9
    v_add_f32 v9, 0x358637bd, v9
    v_rcp_f32 v9, v9
    s_nop 0
    v_mul_f32 v16, v16, v9
    v_mul_f32 v17, v17, v9
    v_mul_f32 v18, v18, v9
    v_mul_f32 v19, v19, v9
    v_mul_f32 v20, v20, v9
    v_mul_f32 v21, v21, v9
    v_mul_f32 v22, v22, v9
    v_mul_f32 v23, v23, v9
    v_mul_f32 v24, v24, v9
    v_mul_f32 v25, v25, v9
    v_mul_f32 v26, v26, v9
    v_mul_f32 v27, v27, v9
    v_mul_f32 v28, v28, v9
    v_mul_f32 v29, v29, v9
    v_mul_f32 v30, v30, v9
    v_mul_f32 v31, v31, v9
    v_cvt_pk_bf16_f32 v96, v16, v17
    v_cvt_pk_bf16_f32 v97, v18, v19
    v_cvt_pk_bf16_f32 v98, v20, v21
    v_cvt_pk_bf16_f32 v99, v22, v23
    v_cvt_pk_bf16_f32 v100, v24, v25
    v_cvt_pk_bf16_f32 v101, v26, v27
    v_cvt_pk_bf16_f32 v102, v28, v29
    v_cvt_pk_bf16_f32 v103, v30, v31
    v_cndmask_b32 v102, v102, 0, s[72:73]
    v_cndmask_b32 v103, v103, 0, s[72:73]
    s_lshl_b32 s57, s78, 2
    s_add_u32 s57, s57, s14
    s_lshl_b32 s57, s57, 15
    s_lshl_b32 s58, s79, 10
    s_add_u32 s57, s57, s58
    s_add_u32 s57, s57, 4194304
    v_lshrrev_b32 v8, 4, v2
    v_lshlrev_b32 v8, 14, v8
    v_lshl_add_u32 v8, v3, 8, v8
    v_and_b32 v10, 15, v2
    v_lshl_add_u32 v8, v10, 4, v8
    v_add_u32 v8, s57, v8
    buffer_store_dwordx4 v[96:99], v8, s[4:7], 0 offen sc0 sc1
    buffer_store_dwordx4 v[100:103], v8, s[4:7], 0 offen offset:512 sc0 sc1
    s_lshl_b32 s57, s78, 2
    s_add_u32 s57, s57, s14
    s_lshl_b32 s57, s57, 4
    s_add_u32 s57, s57, s79
    s_lshl_b32 s57, s57, 3
    s_add_u32 s57, s57, 11558912
    v_mov_b32 v15, s57
    s_cmp_lt_u32 s82, 32
    s_cbranch_scc1 L_p4_15
    s_waitcnt vmcnt(0)
    v_mov_b32 v96, s12
    v_mov_b32 v97, s13
    s_mov_b64 exec, 1
    buffer_store_dwordx2 v[96:97], v15, s[4:7], 0 offen sc0 sc1
    s_mov_b64 exec, -1
    s_endpgm
L_p4_15:
    s_mov_b32 s68, s22
    s_mov_b32 s69, s23
    s_mov_b32 s70, 401408
    s_mov_b32 s71, 0x00020000
    v_lshrrev_b32 v6, 2, v1
    v_and_b32 v7, 3, v1
    v_mul_u32_u24 v9, 896, v6
    v_lshl_add_u32 v9, v7, 4, v9
    s_lshl_b32 s53, s83, 7
    v_add_u32 v9, s53, v9
    s_mul_i32 s55, s14, 14336
    s_add_u32 s57, s55, 0
    s_add_u32 m0, s56, 0
    s_nop 0
    buffer_load_dwordx4 v9, s[68:71], s57 offen lds
    s_add_u32 s57, s55, 64
    s_add_u32 m0, s56, 28672
    s_nop 0
    buffer_load_dwordx4 v9, s[68:71], s57 offen lds
    s_add_u32 s57, s55, 57344
    s_add_u32 m0, s56, 4096
    s_nop 0
    buffer_load_dwordx4 v9, s[68:71], s57 offen lds
    s_add_u32 s57, s55, 57408
    s_add_u32 m0, s56, 32768
    s_nop 0
    buffer_load_dwordx4 v9, s[68:71], s57 offen lds
    s_waitcnt vmcnt(4)
    v_mov_b32 v96, s12
    v_mov_b32 v97, s13
    s_mov_b64 exec, 1
    buffer_store_dwordx2 v[96:97], v15, s[4:7], 0 offen sc0 sc1
    s_mov_b64 exec, -1
    s_add_u32 s57, s55, 114688
    s_add_u32 m0, s56, 8192
    s_nop 0
    buffer_load_dwordx4 v9, s[68:71], s57 offen lds
    s_add_u32 s57, s55, 114752
    s_add_u32 m0, s56, 36864
    s_nop 0
    buffer_load_dwordx4 v9, s[68:71], s57 offen lds
    s_add_u32 s57, s55, 172032
    s_add_u32 m0, s56, 12288
    s_nop 0
    buffer_load_dwordx4 v9, s[68:71], s57 offen lds
    s_add_u32 s57, s55, 172096
    s_add_u32 m0, s56, 40960
    s_nop 0
    buffer_load_dwordx4 v9, s[68:71], s57 offen lds
    s_add_u32 s57, s55, 229376
    s_add_u32 m0, s56, 16384
    s_nop 0
    buffer_load_dwordx4 v9, s[68:71], s57 offen lds
    s_add_u32 s57, s55, 229440
    s_add_u32 m0, s56, 45056
    s_nop 0
    buffer_load_dwordx4 v9, s[68:71], s57 offen lds
    s_add_u32 s57, s55, 286720
    s_add_u32 m0, s56, 20480
    s_nop 0
    buffer_load_dwordx4 v9, s[68:71], s57 offen lds
    s_add_u32 s57, s55, 286784
    s_add_u32 m0, s56, 49152
    s_nop 0
    buffer_load_dwordx4 v9, s[68:71], s57 offen lds
    s_add_u32 s57, s55, 344064
    s_add_u32 m0, s56, 24576
    s_nop 0
    buffer_load_dwordx4 v9, s[68:71], s57 offen lds
    s_add_u32 s57, s55, 344128
    s_add_u32 m0, s56, 53248
    s_nop 0
    buffer_load_dwordx4 v9, s[68:71], s57 offen lds
    v_and_b32 v2, 15, v1
    v_lshrrev_b32 v3, 4, v1
    s_lshl_b32 s57, s82, 6
    s_lshr_b32 s58, s14, 1
    s_lshl_b32 s58, s58, 5
    s_add_u32 s57, s57, s58
    s_and_b32 s58, s14, 1
    s_lshl_b32 s58, s58, 2
    s_add_u32 s57, s57, s58
    v_and_b32 v4, 3, v2
    v_lshlrev_b32 v4, 3, v4
    v_lshrrev_b32 v8, 2, v2
    v_add3_u32 v4, v4, v8, s57
    s_mov_b32 s68, s16
    s_mov_b32 s69, s17
    s_mov_b32 s70, 1835008
    s_mov_b32 s71, 0x00020000
    s_mov_b32 s64, s40
    s_mov_b32 s65, s41
    s_mov_b32 s66, 896
    s_mov_b32 s67, 0x00020000
    s_lshl_b32 s58, s83, 7
    v_lshlrev_b32 v5, 3, v3
    v_add_u32 v5, s58, v5
    v_mul_u32_u24 v6, 896, v4
    v_add_u32 v6, v6, v5
    buffer_load_dwordx2 v[96:97], v6, s[68:71], 0 offen offset:0
    buffer_load_dwordx2 v[104:105], v5, s[64:67], 0 offen offset:0
    buffer_load_dwordx2 v[98:99], v6, s[68:71], 0 offen offset:32
    buffer_load_dwordx2 v[106:107], v5, s[64:67], 0 offen offset:32
    buffer_load_dwordx2 v[100:101], v6, s[68:71], 0 offen offset:64
    buffer_load_dwordx2 v[108:109], v5, s[64:67], 0 offen offset:64
    buffer_load_dwordx2 v[102:103], v6, s[68:71], 0 offen offset:96
    buffer_load_dwordx2 v[110:111], v5, s[64:67], 0 offen offset:96
    v_bfe_u32 v7, v1, 2, 2
    v_lshrrev_b32 v8, 1, v3
    v_lshl_add_u32 v7, v8, 4, v7
    v_and_b32 v8, 1, v3
    v_lshl_add_u32 v7, v8, 2, v7
    v_lshlrev_b32 v7, 6, v7
    v_and_b32 v8, 3, v1
    v_lshl_add_u32 v7, v8, 3, v7
    s_lshr_b32 s57, s82, 1
    s_lshl_b32 s57, s57, 2
    s_and_b32 s58, s82, 1
    s_lshl_b32 s58, s58, 1
    s_add_u32 s57, s57, s58
    s_lshr_b32 s58, s14, 1
    s_add_u32 s57, s57, s58
    s_lshl_b32 s57, s57, 7
    s_add_u32 s57, s57, 11558912
    v_lshlrev_b32 v8, 3, v2
    v_add_u32 v8, s57, v8
    s_lshl_b32 s57, s83, 2
    s_lshr_b32 s58, s82, 3
    s_add_u32 s57, s57, s58
    s_lshl_b32 s57, s57, 8
    s_add_u32 s57, s57, 11542528
    v_and_b32 v10, 31, v1
    v_lshlrev_b32 v10, 3, v10
    v_add_u32 v10, s57, v10
    s_mov_b32 s57, 0
L_pfo_16:
    buffer_load_dwordx2 v[112:113], v8, s[4:7], 0 offen sc0 sc1
    s_waitcnt vmcnt(0)
    v_cmp_eq_u64 vcc, s[12:13], v[112:113]
    s_nop 1
    s_cmp_eq_u32 vcc_lo, -1
    s_cbranch_scc1 L_pfod_17
    s_add_u32 s57, s57, 1
    s_cmp_ge_u32 s57, 200000
    s_cbranch_scc1 L_pfod_17
    s_sleep 1
    s_branch L_pfo_16
L_pfod_17:
    s_mov_b32 s89, 0
    s_lshl_b32 s57, s83, 18
    s_add_u32 s57, s57, 2097152
    v_lshlrev_b32 v12, 14, v3
    v_lshl_add_u32 v12, v4, 2, v12
    v_add_u32 v12, s57, v12
    s_cmp_lg_u32 s89, -1
    s_cbranch_scc1 L_ny_18
    s_mov_b32 s57, 0
    buffer_load_dword v112, v12, s[4:7], s57 offen sc0 sc1
    s_mov_b32 s57, 8192
    buffer_load_dword v113, v12, s[4:7], s57 offen sc0 sc1
    s_mov_b32 s57, 65536
    buffer_load_dword v114, v12, s[4:7], s57 offen sc0 sc1
    s_mov_b32 s57, 73728
    buffer_load_dword v115, v12, s[4:7], s57 offen sc0 sc1
    s_mov_b32 s57, 131072
    buffer_load_dword v116, v12, s[4:7], s57 offen sc0 sc1
    s_mov_b32 s57, 139264
    buffer_load_dword v117, v12, s[4:7], s57 offen sc0 sc1
    s_mov_b32 s57, 196608
    buffer_load_dword v118, v12, s[4:7], s57 offen sc0 sc1
    s_mov_b32 s57, 204800
    buffer_load_dword v119, v12, s[4:7], s57 offen sc0 sc1
L_ny_18:
    s_lshl_b32 s57, s82, 2
    s_add_u32 s57, s57, s14
    s_lshl_b32 s57, s57, 14
    s_add_u32 s57, s57, 4194304
    v_lshlrev_b32 v8, 4, v1
    v_add_u32 v8, s57, v8
    s_movk_i32 s57, 0
    buffer_load_dwordx4 v[144:147], v8, s[4:7], s57 offen sc0 sc1
    s_movk_i32 s57, 1024
    buffer_load_dwordx4 v[148:151], v8, s[4:7], s57 offen sc0 sc1
    s_movk_i32 s57, 2048
    buffer_load_dwordx4 v[152:155], v8, s[4:7], s57 offen sc0 sc1
    s_movk_i32 s57, 3072
    buffer_load_dwordx4 v[156:159], v8, s[4:7], s57 offen sc0 sc1
    s_movk_i32 s57, 4096
    buffer_load_dwordx4 v[160:163], v8, s[4:7], s57 offen sc0 sc1
    s_movk_i32 s57, 5120
    buffer_load_dwordx4 v[164:167], v8, s[4:7], s57 offen sc0 sc1
    s_movk_i32 s57, 6144
    buffer_load_dwordx4 v[168:171], v8, s[4:7], s57 offen sc0 sc1
    s_movk_i32 s57, 7168
    buffer_load_dwordx4 v[172:175], v8, s[4:7], s57 offen sc0 sc1
    s_movk_i32 s57, 8192
    buffer_load_dwordx4 v[176:179], v8, s[4:7], s57 offen sc0 sc1
    s_movk_i32 s57, 9216
    buffer_load_dwordx4 v[180:183], v8, s[4:7], s57 offen sc0 sc1
    s_movk_i32 s57, 10240
    buffer_load_dwordx4 v[184:187], v8, s[4:7], s57 offen sc0 sc1
    s_movk_i32 s57, 11264
    buffer_load_dwordx4 v[188:191], v8, s[4:7], s57 offen sc0 sc1
    s_movk_i32 s57, 12288
    buffer_load_dwordx4 v[192:195], v8, s[4:7], s57 offen sc0 sc1
    s_movk_i32 s57, 13312
    buffer_load_dwordx4 v[196:199], v8, s[4:7], s57 offen sc0 sc1
    s_movk_i32 s57, 14336
    buffer_load_dwordx4 v[200:203], v8, s[4:7], s57 offen sc0 sc1
    s_movk_i32 s57, 15360
    buffer_load_dwordx4 v[204:207], v8, s[4:7], s57 offen sc0 sc1
    v_lshlrev_b32 v9, 2, v4
    v_add_u32 v9, 10485760, v9
    buffer_load_dword v14, v9, s[4:7], 0 offen sc0 sc1
    buffer_load_dwordx2 v[120:121], v10, s[4:7], 0 offen sc0 sc1
    s_barrier
    ds_read_b64_tr_b16 v[32:33], v7 offset:0
    ds_read_b64_tr_b16 v[34:35], v7 offset:512
    ds_read_b64_tr_b16 v[36:37], v7 offset:32
    ds_read_b64_tr_b16 v[38:39], v7 offset:544
    ds_read_b64_tr_b16 v[40:41], v7 offset:28672
    ds_read_b64_tr_b16 v[42:43], v7 offset:29184
    ds_read_b64_tr_b16 v[44:45], v7 offset:28704
    ds_read_b64_tr_b16 v[46:47], v7 offset:29216
    ds_read_b64_tr_b16 v[48:49], v7 offset:1792
    ds_read_b64_tr_b16 v[50:51], v7 offset:2304
    ds_read_b64_tr_b16 v[52:53], v7 offset:1824
    ds_read_b64_tr_b16 v[54:55], v7 offset:2336
    ds_read_b64_tr_b16 v[56:57], v7 offset:30464
    ds_read_b64_tr_b16 v[58:59], v7 offset:30976
    ds_read_b64_tr_b16 v[60:61], v7 offset:30496
    ds_read_b64_tr_b16 v[62:63], v7 offset:31008
    s_waitcnt lgkmcnt(8)
    s_waitcnt vmcnt(17)
    v_mfma_f32_16x16x32_bf16 v[16:19], v[32:35], v[144:147], 0
    v_mfma_f32_16x16x32_bf16 v[20:23], v[36:39], v[144:147], 0
    v_mfma_f32_16x16x32_bf16 v[24:27], v[40:43], v[144:147], 0
    v_mfma_f32_16x16x32_bf16 v[28:31], v[44:47], v[144:147], 0
    ds_read_b64_tr_b16 v[32:33], v7 offset:3584
    ds_read_b64_tr_b16 v[34:35], v7 offset:4096
    ds_read_b64_tr_b16 v[36:37], v7 offset:3616
    ds_read_b64_tr_b16 v[38:39], v7 offset:4128
    ds_read_b64_tr_b16 v[40:41], v7 offset:32256
    ds_read_b64_tr_b16 v[42:43], v7 offset:32768
    ds_read_b64_tr_b16 v[44:45], v7 offset:32288
    ds_read_b64_tr_b16 v[46:47], v7 offset:32800
    s_waitcnt lgkmcnt(8)
    s_waitcnt vmcnt(16)
    v_mfma_f32_16x16x32_bf16 v[16:19], v[48:51], v[148:151], v[16:19]
    v_mfma_f32_16x16x32_bf16 v[20:23], v[52:55], v[148:151], v[20:23]
    v_mfma_f32_16x16x32_bf16 v[24:27], v[56:59], v[148:151], v[24:27]
    v_mfma_f32_16x16x32_bf16 v[28:31], v[60:63], v[148:151], v[28:31]
    ds_read_b64_tr_b16 v[48:49], v7 offset:5376
    ds_read_b64_tr_b16 v[50:51], v7 offset:5888
    ds_read_b64_tr_b16 v[52:53], v7 offset:5408
    ds_read_b64_tr_b16 v[54:55], v7 offset:5920
    ds_read_b64_tr_b16 v[56:57], v7 offset:34048
    ds_read_b64_tr_b16 v[58:59], v7 offset:34560
    ds_read_b64_tr_b16 v[60:61], v7 offset:34080
    ds_read_b64_tr_b16 v[62:63], v7 offset:34592
    s_waitcnt lgkmcnt(8)
    s_waitcnt vmcnt(15)
    v_mfma_f32_16x16x32_bf16 v[16:19], v[32:35], v[152:155], v[16:19]
    v_mfma_f32_16x16x32_bf16 v[20:23], v[36:39], v[152:155], v[20:23]
    v_mfma_f32_16x16x32_bf16 v[24:27], v[40:43], v[152:155], v[24:27]
    v_mfma_f32_16x16x32_bf16 v[28:31], v[44:47], v[152:155], v[28:31]
    ds_read_b64_tr_b16 v[32:33], v7 offset:7168
    ds_read_b64_tr_b16 v[34:35], v7 offset:7680
    ds_read_b64_tr_b16 v[36:37], v7 offset:7200
    ds_read_b64_tr_b16 v[38:39], v7 offset:7712
    ds_read_b64_tr_b16 v[40:41], v7 offset:35840
    ds_read_b64_tr_b16 v[42:43], v7 offset:36352
    ds_read_b64_tr_b16 v[44:45], v7 offset:35872
    ds_read_b64_tr_b16 v[46:47], v7 offset:36384
    s_waitcnt lgkmcnt(8)
    s_waitcnt vmcnt(14)
    v_mfma_f32_16x16x32_bf16 v[16:19], v[48:51], v[156:159], v[16:19]
    v_mfma_f32_16x16x32_bf16 v[20:23], v[52:55], v[156:159], v[20:23]
    v_mfma_f32_16x16x32_bf16 v[24:27], v[56:59], v[156:159], v[24:27]
    v_mfma_f32_16x16x32_bf16 v[28:31], v[60:63], v[156:159], v[28:31]
    ds_read_b64_tr_b16 v[48:49], v7 offset:8960
    ds_read_b64_tr_b16 v[50:51], v7 offset:9472
    ds_read_b64_tr_b16 v[52:53], v7 offset:8992
    ds_read_b64_tr_b16 v[54:55], v7 offset:9504
    ds_read_b64_tr_b16 v[56:57], v7 offset:37632
    ds_read_b64_tr_b16 v[58:59], v7 offset:38144
    ds_read_b64_tr_b16 v[60:61], v7 offset:37664
    ds_read_b64_tr_b16 v[62:63], v7 offset:38176
    s_waitcnt lgkmcnt(8)
    s_waitcnt vmcnt(13)
    v_mfma_f32_16x16x32_bf16 v[16:19], v[32:35], v[160:163], v[16:19]
    v_mfma_f32_16x16x32_bf16 v[20:23], v[36:39], v[160:163], v[20:23]
    v_mfma_f32_16x16x32_bf16 v[24:27], v[40:43], v[160:163], v[24:27]
    v_mfma_f32_16x16x32_bf16 v[28:31], v[44:47], v[160:163], v[28:31]
    ds_read_b64_tr_b16 v[32:33], v7 offset:10752
    ds_read_b64_tr_b16 v[34:35], v7 offset:11264
    ds_read_b64_tr_b16 v[36:37], v7 offset:10784
    ds_read_b64_tr_b16 v[38:39], v7 offset:11296
    ds_read_b64_tr_b16 v[40:41], v7 offset:39424
    ds_read_b64_tr_b16 v[42:43], v7 offset:39936
    ds_read_b64_tr_b16 v[44:45], v7 offset:39456
    ds_read_b64_tr_b16 v[46:47], v7 offset:39968
    s_waitcnt lgkmcnt(8)
    s_waitcnt vmcnt(12)
    v_mfma_f32_16x16x32_bf16 v[16:19], v[48:51], v[164:167], v[16:19]
    v_mfma_f32_16x16x32_bf16 v[20:23], v[52:55], v[164:167], v[20:23]
    v_mfma_f32_16x16x32_bf16 v[24:27], v[56:59], v[164:167], v[24:27]
    v_mfma_f32_16x16x32_bf16 v[28:31], v[60:63], v[164:167], v[28:31]
    ds_read_b64_tr_b16 v[48:49], v7 offset:12544
    ds_read_b64_tr_b16 v[50:51], v7 offset:13056
    ds_read_b64_tr_b16 v[52:53], v7 offset:12576
    ds_read_b64_tr_b16 v[54:55], v7 offset:13088
    ds_read_b64_tr_b16 v[56:57], v7 offset:41216
    ds_read_b64_tr_b16 v[58:59], v7 offset:41728
    ds_read_b64_tr_b16 v[60:61], v7 offset:41248
    ds_read_b64_tr_b16 v[62:63], v7 offset:41760
    s_waitcnt lgkmcnt(8)
    s_waitcnt vmcnt(11)
    v_mfma_f32_16x16x32_bf16 v[16:19], v[32:35], v[168:171], v[16:19]
    v_mfma_f32_16x16x32_bf16 v[20:23], v[36:39], v[168:171], v[20:23]
    v_mfma_f32_16x16x32_bf16 v[24:27], v[40:43], v[168:171], v[24:27]
    v_mfma_f32_16x16x32_bf16 v[28:31], v[44:47], v[168:171], v[28:31]
    ds_read_b64_tr_b16 v[32:33], v7 offset:14336
    ds_read_b64_tr_b16 v[34:35], v7 offset:14848
    ds_read_b64_tr_b16 v[36:37], v7 offset:14368
    ds_read_b64_tr_b16 v[38:39], v7 offset:14880
    ds_read_b64_tr_b16 v[40:41], v7 offset:43008
    ds_read_b64_tr_b16 v[42:43], v7 offset:43520
    ds_read_b64_tr_b16 v[44:45], v7 offset:43040
    ds_read_b64_tr_b16 v[46:47], v7 offset:43552
    s_waitcnt lgkmcnt(8)
    s_waitcnt vmcnt(10)
    v_mfma_f32_16x16x32_bf16 v[16:19], v[48:51], v[172:175], v[16:19]
    v_mfma_f32_16x16x32_bf16 v[20:23], v[52:55], v[172:175], v[20:23]
    v_mfma_f32_16x16x32_bf16 v[24:27], v[56:59], v[172:175], v[24:27]
    v_mfma_f32_16x16x32_bf16 v[28:31], v[60:63], v[172:175], v[28:31]
    ds_read_b64_tr_b16 v[48:49], v7 offset:16128
    ds_read_b64_tr_b16 v[50:51], v7 offset:16640
    ds_read_b64_tr_b16 v[52:53], v7 offset:16160
    ds_read_b64_tr_b16 v[54:55], v7 offset:16672
    ds_read_b64_tr_b16 v[56:57], v7 offset:44800
    ds_read_b64_tr_b16 v[58:59], v7 offset:45312
    ds_read_b64_tr_b16 v[60:61], v7 offset:44832
    ds_read_b64_tr_b16 v[62:63], v7 offset:45344
    s_waitcnt lgkmcnt(8)
    s_waitcnt vmcnt(0)
    v_cmp_eq_u64 vcc, s[12:13], v[120:121]
    s_nop 1
    s_cmp_lg_u64 vcc, exec
    s_cbranch_scc1 L_yc_19
    s_mov_b32 s89, -1
    s_mov_b32 s57, 0
    buffer_load_dword v112, v12, s[4:7], s57 offen sc0 sc1
    s_mov_b32 s57, 8192
    buffer_load_dword v113, v12, s[4:7], s57 offen sc0 sc1
    s_mov_b32 s57, 65536
    buffer_load_dword v114, v12, s[4:7], s57 offen sc0 sc1
    s_mov_b32 s57, 73728
    buffer_load_dword v115, v12, s[4:7], s57 offen sc0 sc1
    s_mov_b32 s57, 131072
    buffer_load_dword v116, v12, s[4:7], s57 offen sc0 sc1
    s_mov_b32 s57, 139264
    buffer_load_dword v117, v12, s[4:7], s57 offen sc0 sc1
    s_mov_b32 s57, 196608
    buffer_load_dword v118, v12, s[4:7], s57 offen sc0 sc1
    s_mov_b32 s57, 204800
    buffer_load_dword v119, v12, s[4:7], s57 offen sc0 sc1
L_yc_19:
    v_mfma_f32_16x16x32_bf16 v[16:19], v[32:35], v[176:179], v[16:19]
    v_mfma_f32_16x16x32_bf16 v[20:23], v[36:39], v[176:179], v[20:23]
    v_mfma_f32_16x16x32_bf16 v[24:27], v[40:43], v[176:179], v[24:27]
    v_mfma_f32_16x16x32_bf16 v[28:31], v[44:47], v[176:179], v[28:31]
    ds_read_b64_tr_b16 v[32:33], v7 offset:17920
    ds_read_b64_tr_b16 v[34:35], v7 offset:18432
    ds_read_b64_tr_b16 v[36:37], v7 offset:17952
    ds_read_b64_tr_b16 v[38:39], v7 offset:18464
    ds_read_b64_tr_b16 v[40:41], v7 offset:46592
    ds_read_b64_tr_b16 v[42:43], v7 offset:47104
    ds_read_b64_tr_b16 v[44:45], v7 offset:46624
    ds_read_b64_tr_b16 v[46:47], v7 offset:47136
    s_waitcnt lgkmcnt(8)
    v_mfma_f32_16x16x32_bf16 v[16:19], v[48:51], v[180:183], v[16:19]
    v_mfma_f32_16x16x32_bf16 v[20:23], v[52:55], v[180:183], v[20:23]
    v_mfma_f32_16x16x32_bf16 v[24:27], v[56:59], v[180:183], v[24:27]
    v_mfma_f32_16x16x32_bf16 v[28:31], v[60:63], v[180:183], v[28:31]
    ds_read_b64_tr_b16 v[48:49], v7 offset:19712
    ds_read_b64_tr_b16 v[50:51], v7 offset:20224
    ds_read_b64_tr_b16 v[52:53], v7 offset:19744
    ds_read_b64_tr_b16 v[54:55], v7 offset:20256
    ds_read_b64_tr_b16 v[56:57], v7 offset:48384
    ds_read_b64_tr_b16 v[58:59], v7 offset:48896
    ds_read_b64_tr_b16 v[60:61], v7 offset:48416
    ds_read_b64_tr_b16 v[62:63], v7 offset:48928
    s_waitcnt lgkmcnt(8)
    v_mfma_f32_16x16x32_bf16 v[16:19], v[32:35], v[184:187], v[16:19]
    v_mfma_f32_16x16x32_bf16 v[20:23], v[36:39], v[184:187], v[20:23]
    v_mfma_f32_16x16x32_bf16 v[24:27], v[40:43], v[184:187], v[24:27]
    v_mfma_f32_16x16x32_bf16 v[28:31], v[44:47], v[184:187], v[28:31]
    ds_read_b64_tr_b16 v[32:33], v7 offset:21504
    ds_read_b64_tr_b16 v[34:35], v7 offset:22016
    ds_read_b64_tr_b16 v[36:37], v7 offset:21536
    ds_read_b64_tr_b16 v[38:39], v7 offset:22048
    ds_read_b64_tr_b16 v[40:41], v7 offset:50176
    ds_read_b64_tr_b16 v[42:43], v7 offset:50688
    ds_read_b64_tr_b16 v[44:45], v7 offset:50208
    ds_read_b64_tr_b16 v[46:47], v7 offset:50720
    s_waitcnt lgkmcnt(8)
    v_mfma_f32_16x16x32_bf16 v[16:19], v[48:51], v[188:191], v[16:19]
    v_mfma_f32_16x16x32_bf16 v[20:23], v[52:55], v[188:191], v[20:23]
    v_mfma_f32_16x16x32_bf16 v[24:27], v[56:59], v[188:191], v[24:27]
    v_mfma_f32_16x16x32_bf16 v[28:31], v[60:63], v[188:191], v[28:31]
    ds_read_b64_tr_b16 v[48:49], v7 offset:23296
    ds_read_b64_tr_b16 v[50:51], v7 offset:23808
    ds_read_b64_tr_b16 v[52:53], v7 offset:23328
    ds_read_b64_tr_b16 v[54:55], v7 offset:23840
    ds_read_b64_tr_b16 v[56:57], v7 offset:51968
    ds_read_b64_tr_b16 v[58:59], v7 offset:52480
    ds_read_b64_tr_b16 v[60:61], v7 offset:52000
    ds_read_b64_tr_b16 v[62:63], v7 offset:52512
    s_waitcnt lgkmcnt(8)
    v_mfma_f32_16x16x32_bf16 v[16:19], v[32:35], v[192:195], v[16:19]
    v_mfma_f32_16x16x32_bf16 v[20:23], v[36:39], v[192:195], v[20:23]
    v_mfma_f32_16x16x32_bf16 v[24:27], v[40:43], v[192:195], v[24:27]
    v_mfma_f32_16x16x32_bf16 v[28:31], v[44:47], v[192:195], v[28:31]
    ds_read_b64_tr_b16 v[32:33], v7 offset:25088
    ds_read_b64_tr_b16 v[34:35], v7 offset:25600
    ds_read_b64_tr_b16 v[36:37], v7 offset:25120
    ds_read_b64_tr_b16 v[38:39], v7 offset:25632
    ds_read_b64_tr_b16 v[40:41], v7 offset:53760
    ds_read_b64_tr_b16 v[42:43], v7 offset:54272
    ds_read_b64_tr_b16 v[44:45], v7 offset:53792
    ds_read_b64_tr_b16 v[46:47], v7 offset:54304
    s_waitcnt lgkmcnt(8)
    v_mfma_f32_16x16x32_bf16 v[16:19], v[48:51], v[196:199], v[16:19]
    v_mfma_f32_16x16x32_bf16 v[20:23], v[52:55], v[196:199], v[20:23]
    v_mfma_f32_16x16x32_bf16 v[24:27], v[56:59], v[196:199], v[24:27]
    v_mfma_f32_16x16x32_bf16 v[28:31], v[60:63], v[196:199], v[28:31]
    ds_read_b64_tr_b16 v[48:49], v7 offset:26880
    ds_read_b64_tr_b16 v[50:51], v7 offset:27392
    ds_read_b64_tr_b16 v[52:53], v7 offset:26912
    ds_read_b64_tr_b16 v[54:55], v7 offset:27424
    ds_read_b64_tr_b16 v[56:57], v7 offset:55552
    ds_read_b64_tr_b16 v[58:59], v7 offset:56064
    ds_read_b64_tr_b16 v[60:61], v7 offset:55584
    ds_read_b64_tr_b16 v[62:63], v7 offset:56096
    s_waitcnt lgkmcnt(8)
    v_mfma_f32_16x16x32_bf16 v[16:19], v[32:35], v[200:203], v[16:19]
    v_mfma_f32_16x16x32_bf16 v[20:23], v[36:39], v[200:203], v[20:23]
    v_mfma_f32_16x16x32_bf16 v[24:27], v[40:43], v[200:203], v[24:27]
    v_mfma_f32_16x16x32_bf16 v[28:31], v[44:47], v[200:203], v[28:31]
    s_waitcnt lgkmcnt(0)
    v_mfma_f32_16x16x32_bf16 v[16:19], v[48:51], v[204:207], v[16:19]
    v_mfma_f32_16x16x32_bf16 v[20:23], v[52:55], v[204:207], v[20:23]
    v_mfma_f32_16x16x32_bf16 v[24:27], v[56:59], v[204:207], v[24:27]
    v_mfma_f32_16x16x32_bf16 v[28:31], v[60:63], v[204:207], v[28:31]
    s_cmp_eq_u32 s89, -1
    s_cbranch_scc1 L_ny2_20
    s_mov_b32 s57, 0
L_poll_21:
    buffer_load_dwordx2 v[120:121], v10, s[4:7], 0 offen sc0 sc1
    s_waitcnt vmcnt(0)
    v_cmp_eq_u64 vcc, s[12:13], v[120:121]
    s_nop 1
    s_cmp_eq_u64 vcc, exec
    s_cbranch_scc1 L_polld_22
    s_add_u32 s57, s57, 1
    s_cmp_ge_u32 s57, 200000
    s_cbranch_scc1 L_polld_22
    s_sleep 1
    s_branch L_poll_21
L_polld_22:
    s_mov_b32 s57, 0
    buffer_load_dword v112, v12, s[4:7], s57 offen sc0 sc1
    s_mov_b32 s57, 8192
    buffer_load_dword v113, v12, s[4:7], s57 offen sc0 sc1
    s_mov_b32 s57, 65536
    buffer_load_dword v114, v12, s[4:7], s57 offen sc0 sc1
    s_mov_b32 s57, 73728
    buffer_load_dword v115, v12, s[4:7], s57 offen sc0 sc1
    s_mov_b32 s57, 131072
    buffer_load_dword v116, v12, s[4:7], s57 offen sc0 sc1
    s_mov_b32 s57, 139264
    buffer_load_dword v117, v12, s[4:7], s57 offen sc0 sc1
    s_mov_b32 s57, 196608
    buffer_load_dword v118, v12, s[4:7], s57 offen sc0 sc1
    s_mov_b32 s57, 204800
    buffer_load_dword v119, v12, s[4:7], s57 offen sc0 sc1
L_ny2_20:
    s_mov_b32 s68, s44
    s_mov_b32 s69, s45
    s_mov_b32 s70, 1835008
    s_mov_b32 s71, 0x00020000
    s_waitcnt vmcnt(0)
    v_sub_f32 v15, 1.0, v14
    v_lshlrev_b32 v64, 16, v96
    v_and_b32 v65, 0xffff0000, v96
    v_lshlrev_b32 v68, 16, v104
    v_and_b32 v69, 0xffff0000, v104
    v_lshlrev_b32 v72, 16, v112
    v_and_b32 v73, 0xffff0000, v112
    v_lshlrev_b32 v66, 16, v97
    v_and_b32 v67, 0xffff0000, v97
    v_lshlrev_b32 v70, 16, v105
    v_and_b32 v71, 0xffff0000, v105
    v_lshlrev_b32 v74, 16, v113
    v_and_b32 v75, 0xffff0000, v113
    v_fma_f32 v72, v64, v68, v72
    v_mul_f32 v72, v15, v72
    v_fma_f32 v72, v14, v16, v72
    v_fma_f32 v73, v65, v69, v73
    v_mul_f32 v73, v15, v73
    v_fma_f32 v73, v14, v17, v73
    v_fma_f32 v74, v66, v70, v74
    v_mul_f32 v74, v15, v74
    v_fma_f32 v74, v14, v18, v74
    v_fma_f32 v75, v67, v71, v75
    v_mul_f32 v75, v15, v75
    v_fma_f32 v75, v14, v19, v75
    v_cvt_pk_bf16_f32 v80, v72, v73
    v_cvt_pk_bf16_f32 v81, v74, v75
    buffer_store_dwordx2 v[80:81], v6, s[68:71], 0 offen offset:0
    v_lshlrev_b32 v64, 16, v98
    v_and_b32 v65, 0xffff0000, v98
    v_lshlrev_b32 v68, 16, v106
    v_and_b32 v69, 0xffff0000, v106
    v_lshlrev_b32 v72, 16, v114
    v_and_b32 v73, 0xffff0000, v114
    v_lshlrev_b32 v66, 16, v99
    v_and_b32 v67, 0xffff0000, v99
    v_lshlrev_b32 v70, 16, v107
    v_and_b32 v71, 0xffff0000, v107
    v_lshlrev_b32 v74, 16, v115
    v_and_b32 v75, 0xffff0000, v115
    v_fma_f32 v72, v64, v68, v72
    v_mul_f32 v72, v15, v72
    v_fma_f32 v72, v14, v20, v72
    v_fma_f32 v73, v65, v69, v73
    v_mul_f32 v73, v15, v73
    v_fma_f32 v73, v14, v21, v73
    v_fma_f32 v74, v66, v70, v74
    v_mul_f32 v74, v15, v74
    v_fma_f32 v74, v14, v22, v74
    v_fma_f32 v75, v67, v71, v75
    v_mul_f32 v75, v15, v75
    v_fma_f32 v75, v14, v23, v75
    v_cvt_pk_bf16_f32 v82, v72, v73
    v_cvt_pk_bf16_f32 v83, v74, v75
    buffer_store_dwordx2 v[82:83], v6, s[68:71], 0 offen offset:32
    v_lshlrev_b32 v64, 16, v100
    v_and_b32 v65, 0xffff0000, v100
    v_lshlrev_b32 v68, 16, v108
    v_and_b32 v69, 0xffff0000, v108
    v_lshlrev_b32 v72, 16, v116
    v_and_b32 v73, 0xffff0000, v116
    v_lshlrev_b32 v66, 16, v101
    v_and_b32 v67, 0xffff0000, v101
    v_lshlrev_b32 v70, 16, v109
    v_and_b32 v71, 0xffff0000, v109
    v_lshlrev_b32 v74, 16, v117
    v_and_b32 v75, 0xffff0000, v117
    v_fma_f32 v72, v64, v68, v72
    v_mul_f32 v72, v15, v72
    v_fma_f32 v72, v14, v24, v72
    v_fma_f32 v73, v65, v69, v73
    v_mul_f32 v73, v15, v73
    v_fma_f32 v73, v14, v25, v73
    v_fma_f32 v74, v66, v70, v74
    v_mul_f32 v74, v15, v74
    v_fma_f32 v74, v14, v26, v74
    v_fma_f32 v75, v67, v71, v75
    v_mul_f32 v75, v15, v75
    v_fma_f32 v75, v14, v27, v75
    v_cvt_pk_bf16_f32 v84, v72, v73
    v_cvt_pk_bf16_f32 v85, v74, v75
    buffer_store_dwordx2 v[84:85], v6, s[68:71], 0 offen offset:64
    v_lshlrev_b32 v64, 16, v102
    v_and_b32 v65, 0xffff0000, v102
    v_lshlrev_b32 v68, 16, v110
    v_and_b32 v69, 0xffff0000, v110
    v_lshlrev_b32 v72, 16, v118
    v_and_b32 v73, 0xffff0000, v118
    v_lshlrev_b32 v66, 16, v103
    v_and_b32 v67, 0xffff0000, v103
    v_lshlrev_b32 v70, 16, v111
    v_and_b32 v71, 0xffff0000, v111
    v_lshlrev_b32 v74, 16, v119
    v_and_b32 v75, 0xffff0000, v119
    v_fma_f32 v72, v64, v68, v72
    v_mul_f32 v72, v15, v72
    v_fma_f32 v72, v14, v28, v72
    v_fma_f32 v73, v65, v69, v73
    v_mul_f32 v73, v15, v73
    v_fma_f32 v73, v14, v29, v73
    v_fma_f32 v74, v66, v70, v74
    v_mul_f32 v74, v15, v74
    v_fma_f32 v74, v14, v30, v74
    v_fma_f32 v75, v67, v71, v75
    v_mul_f32 v75, v15, v75
    v_fma_f32 v75, v14, v31, v75
    v_cvt_pk_bf16_f32 v86, v72, v73
    v_cvt_pk_bf16_f32 v87, v74, v75
    buffer_store_dwordx2 v[86:87], v6, s[68:71], 0 offen offset:96
    s_endpgm
L_exit:
    s_endpgm
L_end:
.section .rodata,"a"
.p2align 6
.amdhsa_kernel gated_mix__linear_kernel_hedgehog__ssm_conv_s4__prompt_kernel
  .amdhsa_next_free_vgpr 256
  .amdhsa_next_free_sgpr 102
  .amdhsa_accum_offset 256
  .amdhsa_group_segment_fixed_size 0
  .amdhsa_kernarg_size 136
  .amdhsa_user_sgpr_count 2
  .amdhsa_user_sgpr_kernarg_segment_ptr 1
  .amdhsa_system_sgpr_workgroup_id_x 1
.end_amdhsa_kernel
```
